```python
import torch

def _softmax(x, axis=-1):
    return torch.softmax(x, dim=axis)
def _gelu(x):
    return torch.nn.functional.gelu(x, approximate="tanh")
def _silu(x):
    return torch.nn.functional.silu(x)
def _sigmoid(x):
    return torch.sigmoid(x)
def _layernorm(x, axis=-1, eps=1e-5):
    m = x.mean(dim=axis, keepdim=True)
    v = x.var(dim=axis, keepdim=True, unbiased=False)
    return (x - m) / torch.sqrt(v + eps)
def _scatter_add(tgt, idx, src, axis=0):
    return tgt.clone().index_add_(axis, idx, src)
def _segment_sum(src, seg, n):
    out = torch.zeros((n,) + src.shape[1:], dtype=src.dtype)
    return out.index_add_(0, seg, src)
def _pad(x, pw):
    flat = tuple(v for pair in reversed(pw) for v in pair)
    return torch.nn.functional.pad(x, flat)

kernel_name = 'gated_mix__gqa_block_cached__dense_activation_relu__decode'

def setup_inputs():

    _w = (lambda a: (lambda t: t.to(torch.bfloat16) if t.is_floating_point() else t)(torch.as_tensor(a)))
    def _A_setup():
        B, Sq, D = 4, 1, 448
        Hq, Hkv, Sk, Dh = 16, 8, 4096, 256
        assert Hq % Hkv == 0, (Hq, Hkv)
        return {
            "x": _w((lambda *s: torch.randn(*s, dtype=torch.bfloat16) * 0.05)(B, Sq, D)),
            "k_cache": _w((lambda *s: torch.randn(*s, dtype=torch.bfloat16) * 6.4)(B, Hkv, Sk, Dh)),
            "v_cache": _w((lambda *s: torch.randn(*s, dtype=torch.bfloat16) * 0.4)(B, Hkv, Sk, Dh)),
            "wq": _w((lambda *s: torch.randn(*s, dtype=torch.bfloat16) * 6.4)(D, Hq * Dh) * (D ** -0.5)),
            "wo": _w((lambda *s: torch.randn(*s, dtype=torch.bfloat16) * 0.4)(Hq * Dh, D) * ((Hq * Dh) ** -0.5)),
        }
    _A_in = _A_setup()

    def _B_setup():
        B, S, D, Dff = 4, 1, 448, 1792
        return {
            "x": _w((lambda *s: torch.randn(*s, dtype=torch.bfloat16) * 0.05)(B, S, D)),
            "w1": _w((lambda *s: torch.randn(*s, dtype=torch.bfloat16) * 0.05)(D, Dff)),
            "w2": _w((lambda *s: torch.randn(*s, dtype=torch.bfloat16) * 0.05)(Dff, D)),
        }
    _B_in = _B_setup()

    return {
        "A_x": _A_in["x"],
        "A_k_cache": _A_in["k_cache"],
        "A_v_cache": _A_in["v_cache"],
        "A_wq": _A_in["wq"],
        "A_wo": _A_in["wo"],
        "B_x": _B_in["x"],
        "B_w1": _B_in["w1"],
        "B_w2": _B_in["w2"],
        "gate_w": _w((lambda *s: torch.randn(*s, dtype=torch.bfloat16) * 0.05)(448) * 16.0),
    }

def reference(A_x, A_k_cache, A_v_cache, A_wq, A_wo, B_x, B_w1, B_w2, gate_w):
    def _A_ref(x, k_cache, v_cache, wq, wo):
        B, Sq, D = x.shape
        Hq, Dh = 16, 256
        Hkv = k_cache.shape[1]
        rep = Hq // Hkv
        q = (lambda x, *d: x.permute(*d))((x @ wq).reshape(B, Sq, Hq, Dh), 0, 2, 1, 3)
        k = (lambda x, n, axis: torch.repeat_interleave(x, n, dim=axis))(k_cache, rep, axis=1)
        v = (lambda x, n, axis: torch.repeat_interleave(x, n, dim=axis))(v_cache, rep, axis=1)
        scores = torch.einsum("bhqd,bhkd->bhqk", q, k) * (Dh ** -0.5)
        p = _softmax(scores, axis=-1)
        o = torch.einsum("bhqk,bhkd->bhqd", p, v)
        return (lambda x, *d: x.permute(*d))(o, 0, 2, 1, 3).reshape(B, Sq, Hq * Dh) @ wo

    def _B_ref(x, w1, w2):
        h = torch.einsum("bsd,df->bsf", x, w1)
        zero = torch.zeros_like(h)
        h = torch.maximum(h, zero)
        return torch.einsum("bsf,fd->bsd", h, w2)

    x = A_x
    g = _sigmoid((x * gate_w).sum(-1, keepdims=True))
    a = _A_ref(x, A_k_cache, A_v_cache, A_wq, A_wo)
    b = _B_ref(x, B_w1, B_w2)
    return g * a + (1 - g) * b
```

```asm
; @launch grid=(256,1,1) block=(256,1,1) lds=99072
.amdgcn_target "amdgcn-amd-amdhsa--gfx950"
.text
.globl gated_mix__gqa_block_cached__dense_activation_relu__decode_kernel
.p2align 8
.type gated_mix__gqa_block_cached__dense_activation_relu__decode_kernel,@function
gated_mix__gqa_block_cached__dense_activation_relu__decode_kernel:
    s_cmp_ge_u32 s2, 256
    s_cbranch_scc1 L_exit
    s_load_dwordx16 s[4:19], s[0:1], 0
    s_load_dwordx8 s[20:27], s[0:1], 64
    v_lshrrev_b32 v93, 6, v0
    v_and_b32 v1, 63, v0
    s_and_b32 s68, s2, 7
    v_readfirstlane_b32 s71, v93
    s_lshr_b32 s75, s2, 3
    v_bfe_u32 v98, v1, 2, 2
    s_and_b32 s69, s75, 7
    v_lshrrev_b32 v99, 4, v1
    s_lshr_b32 s70, s75, 3
    v_and_b32 v100, 3, v1
    s_lshl_b32 s74, s70, 3
    v_lshlrev_b32 v2, 9, v98
    s_add_u32 s74, s74, s68
    v_lshl_add_u32 v2, v99, 6, v2
    s_lshl_b32 s77, s71, 11
    v_lshl_add_u32 v2, v100, 4, v2
    s_lshl_b32 s78, s74, 21
    v_add_u32 v2, s77, v2
    s_lshl_b32 s76, s69, 18
    s_add_u32 s78, s78, s76
    s_waitcnt lgkmcnt(0)
    s_add_u32 s40, s6, s78
    s_addc_u32 s41, s7, 0
    s_mov_b32 s42, 262144
    s_mov_b32 s43, 0x20000
    s_lshl_b32 s80, s68, 2
    s_add_u32 s80, s80, s70
    s_lshl_b32 s80, s80, 13
    buffer_load_dwordx4 a[0:3], v2, s[40:43], s80 offen offset:0 nt
    buffer_load_dwordx4 a[4:7], v2, s[40:43], s80 offen offset:256 nt
    s_lshl_b32 s73, s68, 3
    s_add_u32 s73, s73, s69
    v_lshrrev_b32 v94, 3, v1
    v_and_b32 v96, 7, v1
    v_lshlrev_b32 v91, 4, v1
    v_mul_u32_u24 v97, 14, v94
    s_mul_i32 s76, s71, 112
    v_add_u32 v97, s76, v97
    v_lshlrev_b32 v90, 1, v97
    v_lshlrev_b32 v88, 13, v97
    v_lshl_add_u32 v88, v96, 4, v88
    v_mul_u32_u24 v89, 3584, v97
    v_lshl_add_u32 v89, v96, 3, v89
    v_and_b32 v101, 15, v1
    s_lshl_b32 s77, s71, 11
    v_lshlrev_b32 v3, 9, v99
    v_lshl_add_u32 v3, v101, 4, v3
    v_add_u32 v3, s77, v3
    s_mul_i32 s76, s70, 896
    s_add_u32 s28, s4, s76
    s_addc_u32 s29, s5, 0
    s_mov_b32 s30, 896
    s_mov_b32 s31, 0x20000
    buffer_load_dwordx4 v[212:215], v90, s[28:31], 0 offen
    buffer_load_dwordx3 v[216:218], v90, s[28:31], 0 offen offset:16
    s_lshl_b32 s76, s73, 7
    s_add_u32 s32, s10, s76
    s_addc_u32 s33, s11, 0
    s_mov_b32 s35, 0x20000
    s_sub_u32 s34, 3670016, s76
    s_mov_b32 s14, 0
    buffer_load_dwordx4 v[128:131], v88, s[32:35], s14 offen nt
    s_add_u32 s80, s80, 8192
    s_and_b32 s80, s80, 0x3ffff
    buffer_load_dwordx4 a[8:11], v2, s[40:43], s80 offen offset:0 nt
    s_add_u32 s14, s14, 8192
    buffer_load_dwordx4 v[132:135], v88, s[32:35], s14 offen nt
    buffer_load_dwordx4 a[12:15], v2, s[40:43], s80 offen offset:256 nt
    s_add_u32 s14, s14, 8192
    buffer_load_dwordx4 v[136:139], v88, s[32:35], s14 offen nt
    s_add_u32 s80, s80, 8192
    s_and_b32 s80, s80, 0x3ffff
    buffer_load_dwordx4 a[16:19], v2, s[40:43], s80 offen offset:0 nt
    s_add_u32 s14, s14, 8192
    buffer_load_dwordx4 v[140:143], v88, s[32:35], s14 offen nt
    buffer_load_dwordx4 a[20:23], v2, s[40:43], s80 offen offset:256 nt
    s_add_u32 s14, s14, 8192
    buffer_load_dwordx4 v[144:147], v88, s[32:35], s14 offen nt
    s_add_u32 s80, s80, 8192
    s_and_b32 s80, s80, 0x3ffff
    buffer_load_dwordx4 a[24:27], v2, s[40:43], s80 offen offset:0 nt
    s_add_u32 s14, s14, 8192
    buffer_load_dwordx4 v[148:151], v88, s[32:35], s14 offen nt
    buffer_load_dwordx4 a[28:31], v2, s[40:43], s80 offen offset:256 nt
    s_add_u32 s14, s14, 8192
    buffer_load_dwordx4 v[152:155], v88, s[32:35], s14 offen nt
    s_add_u32 s80, s80, 8192
    s_and_b32 s80, s80, 0x3ffff
    buffer_load_dwordx4 a[32:35], v2, s[40:43], s80 offen offset:0 nt
    s_add_u32 s14, s14, 8192
    buffer_load_dwordx4 v[156:159], v88, s[32:35], s14 offen nt
    buffer_load_dwordx4 a[36:39], v2, s[40:43], s80 offen offset:256 nt
    s_add_u32 s14, s14, 8192
    buffer_load_dwordx4 v[160:163], v88, s[32:35], s14 offen nt
    s_add_u32 s80, s80, 8192
    s_and_b32 s80, s80, 0x3ffff
    buffer_load_dwordx4 a[40:43], v2, s[40:43], s80 offen offset:0 nt
    s_add_u32 s14, s14, 8192
    buffer_load_dwordx4 v[164:167], v88, s[32:35], s14 offen nt
    buffer_load_dwordx4 a[44:47], v2, s[40:43], s80 offen offset:256 nt
    s_add_u32 s14, s14, 8192
    buffer_load_dwordx4 v[168:171], v88, s[32:35], s14 offen nt
    s_add_u32 s80, s80, 8192
    s_and_b32 s80, s80, 0x3ffff
    buffer_load_dwordx4 a[48:51], v2, s[40:43], s80 offen offset:0 nt
    s_add_u32 s14, s14, 8192
    buffer_load_dwordx4 v[172:175], v88, s[32:35], s14 offen nt
    buffer_load_dwordx4 a[52:55], v2, s[40:43], s80 offen offset:256 nt
    s_add_u32 s14, s14, 8192
    buffer_load_dwordx4 v[176:179], v88, s[32:35], s14 offen nt
    s_add_u32 s80, s80, 8192
    s_and_b32 s80, s80, 0x3ffff
    buffer_load_dwordx4 a[56:59], v2, s[40:43], s80 offen offset:0 nt
    s_add_u32 s14, s14, 8192
    buffer_load_dwordx4 v[180:183], v88, s[32:35], s14 offen nt
    buffer_load_dwordx4 a[60:63], v2, s[40:43], s80 offen offset:256 nt
    s_lshr_b32 s75, s10, 7
    s_add_u32 s75, s75, s69
    s_sub_u32 s75, s75, 4
    s_and_b32 s77, s75, 7
    s_mul_i32 s75, s68, 7
    s_add_u32 s75, s75, s77
    s_lshl_b32 s76, s75, 6
    s_add_u32 s36, s16, s76
    s_addc_u32 s37, s17, 0
    s_mov_b32 s39, 0x20000
    s_sub_u32 s38, 1605632, s76
    s_mul_i32 s76, s75, 28672
    s_add_u32 s52, s18, s76
    s_addc_u32 s53, s19, 0
    s_mov_b32 s54, 28672
    s_mov_b32 s55, 0x20000
    s_cmp_eq_u32 s77, 7
    s_cselect_b32 s38, 0, s38
    s_cselect_b32 s54, 0, s54
    s_mov_b32 s56, s20
    s_mov_b32 s57, s21
    s_mov_b32 s58, 896
    s_mov_b32 s59, 0x20000
    s_mov_b32 s15, 0
    buffer_load_dwordx2 v[184:185], v89, s[36:39], s15 offen
    s_add_u32 s80, s80, 8192
    s_and_b32 s80, s80, 0x3ffff
    buffer_load_dwordx4 a[64:67], v2, s[40:43], s80 offen offset:0 nt
    s_add_u32 s15, s15, 3584
    buffer_load_dwordx2 v[186:187], v89, s[36:39], s15 offen
    buffer_load_dwordx4 a[68:71], v2, s[40:43], s80 offen offset:256 nt
    s_add_u32 s15, s15, 3584
    buffer_load_dwordx2 v[188:189], v89, s[36:39], s15 offen
    s_add_u32 s80, s80, 8192
    s_and_b32 s80, s80, 0x3ffff
    buffer_load_dwordx4 a[72:75], v2, s[40:43], s80 offen offset:0 nt
    s_add_u32 s15, s15, 3584
    buffer_load_dwordx2 v[190:191], v89, s[36:39], s15 offen
    buffer_load_dwordx4 a[76:79], v2, s[40:43], s80 offen offset:256 nt
    s_add_u32 s15, s15, 3584
    buffer_load_dwordx2 v[192:193], v89, s[36:39], s15 offen
    s_add_u32 s80, s80, 8192
    s_and_b32 s80, s80, 0x3ffff
    buffer_load_dwordx4 a[80:83], v2, s[40:43], s80 offen offset:0 nt
    s_add_u32 s15, s15, 3584
    buffer_load_dwordx2 v[194:195], v89, s[36:39], s15 offen
    buffer_load_dwordx4 a[84:87], v2, s[40:43], s80 offen offset:256 nt
    s_lshl_b32 s76, s74, 21
    s_lshl_b32 s77, s69, 18
    s_add_u32 s76, s76, s77
    s_add_u32 s44, s8, s76
    s_addc_u32 s45, s9, 0
    s_mov_b32 s46, 262144
    s_mov_b32 s47, 0x20000
    s_lshl_b32 s75, s70, 8
    s_load_dword s72, s[26:27], s75
    s_mov_b32 s60, s26
    s_mov_b32 s61, s27
    s_mov_b32 s62, 6291456
    s_mov_b32 s63, 0x20000
    s_mov_b32 s64, s22
    s_mov_b32 s65, s23
    s_mov_b32 s66, 3584
    s_mov_b32 s67, 0x20000
    s_mov_b32 s82, 0x3db8aa3b
    s_mov_b32 s83, 0x01000100
    s_mov_b32 s84, 0x03020302
    v_and_b32 v93, 1, v1
    v_lshlrev_b32 v93, 4, v93
    v_mov_b32 v94, 0xffff
    v_lshlrev_b32 v93, v93, v94
    v_bfe_u32 v96, v1, 1, 2
    v_bfe_u32 v97, v1, 1, 1
    v_bfe_u32 v98, v1, 3, 1
    v_lshl_add_u32 v98, v98, 1, v97
    v_cmp_eq_u32 s[86:87], 0, v96
    v_cmp_eq_u32 s[88:89], 1, v96
    v_cmp_eq_u32 s[90:91], 2, v96
    v_cmp_eq_u32 s[92:93], 3, v96
    v_cndmask_b32 v220, 0, v93, s[86:87]
    v_cndmask_b32 v221, 0, v93, s[88:89]
    v_cndmask_b32 v222, 0, v93, s[90:91]
    v_cndmask_b32 v223, 0, v93, s[92:93]
    v_cmp_eq_u32 s[86:87], 0, v97
    v_cmp_eq_u32 s[88:89], 1, v97
    s_nop 0
    v_cndmask_b32 v224, 0, v93, s[86:87]
    v_cndmask_b32 v225, 0, v93, s[88:89]
    v_cmp_eq_u32 s[86:87], 0, v98
    v_cmp_eq_u32 s[88:89], 1, v98
    v_cmp_eq_u32 s[90:91], 2, v98
    v_cmp_eq_u32 s[92:93], 3, v98
    v_cndmask_b32 v4, 0, v93, s[86:87]
    v_cndmask_b32 v5, 0, v93, s[88:89]
    v_cndmask_b32 v6, 0, v93, s[90:91]
    v_cndmask_b32 v7, 0, v93, s[92:93]
    s_waitcnt lgkmcnt(0)
    s_add_u32 s72, s72, 0x9e3779b9
    s_waitcnt vmcnt(40)
    v_perm_b32 v226, v212, v212, s83
    v_and_b32 v228, v226, v220
    v_and_b32 v229, v226, v221
    v_and_b32 v230, v226, v222
    v_and_b32 v231, v226, v223
    v_perm_b32 v226, v212, v212, s84
    v_and_b32 v232, v226, v220
    v_and_b32 v233, v226, v221
    v_and_b32 v234, v226, v222
    v_and_b32 v235, v226, v223
    s_waitcnt vmcnt(39)
    v_mfma_f32_16x16x32_bf16 v[240:243], v[228:231], v[128:131], 0
    v_perm_b32 v226, v213, v213, s83
    v_and_b32 v228, v226, v220
    v_and_b32 v229, v226, v221
    v_and_b32 v230, v226, v222
    v_and_b32 v231, v226, v223
    s_waitcnt vmcnt(37)
    v_mfma_f32_16x16x32_bf16 v[240:243], v[232:235], v[132:135], v[240:243]
    v_perm_b32 v226, v213, v213, s84
    v_and_b32 v232, v226, v220
    v_and_b32 v233, v226, v221
    v_and_b32 v234, v226, v222
    v_and_b32 v235, v226, v223
    s_waitcnt vmcnt(35)
    v_mfma_f32_16x16x32_bf16 v[240:243], v[228:231], v[136:139], v[240:243]
    v_perm_b32 v226, v214, v214, s83
    v_and_b32 v228, v226, v220
    v_and_b32 v229, v226, v221
    v_and_b32 v230, v226, v222
    v_and_b32 v231, v226, v223
    s_waitcnt vmcnt(33)
    v_mfma_f32_16x16x32_bf16 v[240:243], v[232:235], v[140:143], v[240:243]
    v_perm_b32 v226, v214, v214, s84
    v_and_b32 v232, v226, v220
    v_and_b32 v233, v226, v221
    v_and_b32 v234, v226, v222
    v_and_b32 v235, v226, v223
    s_waitcnt vmcnt(31)
    v_mfma_f32_16x16x32_bf16 v[240:243], v[228:231], v[144:147], v[240:243]
    v_perm_b32 v226, v215, v215, s83
    v_and_b32 v228, v226, v220
    v_and_b32 v229, v226, v221
    v_and_b32 v230, v226, v222
    v_and_b32 v231, v226, v223
    s_waitcnt vmcnt(29)
    v_mfma_f32_16x16x32_bf16 v[240:243], v[232:235], v[148:151], v[240:243]
    v_perm_b32 v226, v215, v215, s84
    v_and_b32 v232, v226, v220
    v_and_b32 v233, v226, v221
    v_and_b32 v234, v226, v222
    v_and_b32 v235, v226, v223
    s_waitcnt vmcnt(27)
    v_mfma_f32_16x16x32_bf16 v[240:243], v[228:231], v[152:155], v[240:243]
    v_perm_b32 v226, v216, v216, s83
    v_and_b32 v228, v226, v220
    v_and_b32 v229, v226, v221
    v_and_b32 v230, v226, v222
    v_and_b32 v231, v226, v223
    s_waitcnt vmcnt(25)
    v_mfma_f32_16x16x32_bf16 v[240:243], v[232:235], v[156:159], v[240:243]
    v_perm_b32 v226, v216, v216, s84
    v_and_b32 v232, v226, v220
    v_and_b32 v233, v226, v221
    v_and_b32 v234, v226, v222
    v_and_b32 v235, v226, v223
    s_waitcnt vmcnt(23)
    v_mfma_f32_16x16x32_bf16 v[240:243], v[228:231], v[160:163], v[240:243]
    v_perm_b32 v226, v217, v217, s83
    v_and_b32 v228, v226, v220
    v_and_b32 v229, v226, v221
    v_and_b32 v230, v226, v222
    v_and_b32 v231, v226, v223
    s_waitcnt vmcnt(21)
    v_mfma_f32_16x16x32_bf16 v[240:243], v[232:235], v[164:167], v[240:243]
    v_perm_b32 v226, v217, v217, s84
    v_and_b32 v232, v226, v220
    v_and_b32 v233, v226, v221
    v_and_b32 v234, v226, v222
    v_and_b32 v235, v226, v223
    s_waitcnt vmcnt(19)
    v_mfma_f32_16x16x32_bf16 v[240:243], v[228:231], v[168:171], v[240:243]
    v_perm_b32 v226, v218, v218, s83
    v_and_b32 v228, v226, v220
    v_and_b32 v229, v226, v221
    v_and_b32 v230, v226, v222
    v_and_b32 v231, v226, v223
    s_waitcnt vmcnt(17)
    v_mfma_f32_16x16x32_bf16 v[240:243], v[232:235], v[172:175], v[240:243]
    v_perm_b32 v226, v218, v218, s84
    v_and_b32 v232, v226, v220
    v_and_b32 v233, v226, v221
    v_and_b32 v234, v226, v222
    v_and_b32 v235, v226, v223
    s_waitcnt vmcnt(15)
    v_mfma_f32_16x16x32_bf16 v[240:243], v[228:231], v[176:179], v[240:243]
    s_waitcnt vmcnt(13)
    v_mfma_f32_16x16x32_bf16 v[240:243], v[232:235], v[180:183], v[240:243]
    v_lshrrev_b32 v93, 5, v1
    s_lshl_b32 s75, s71, 1
    v_add_u32 v93, s75, v93
    v_lshlrev_b32 v93, 8, v93
    v_and_b32 v94, 7, v1
    v_lshl_add_u32 v93, v94, 5, v93
    v_bfe_u32 v94, v1, 4, 1
    v_lshl_add_u32 v93, v94, 4, v93
    s_mov_b32 exec_lo, 0x00ff00ff
    s_mov_b32 exec_hi, 0xff00ff00
    ds_write_b128 v93, v[240:243] offset:0
    s_mov_b64 exec, -1
    s_waitcnt lgkmcnt(0)
    s_barrier
    s_cmp_lg_u32 s71, 0
    s_cbranch_scc1 L_qpub_done
    s_mov_b64 exec, 0xffff
    ds_read_b128 v[96:99], v91 offset:0
    ds_read_b128 v[100:103], v91 offset:256
    ds_read_b128 v[104:107], v91 offset:512
    ds_read_b128 v[108:111], v91 offset:768
    ds_read_b128 v[112:115], v91 offset:1024
    ds_read_b128 v[116:119], v91 offset:1280
    ds_read_b128 v[120:123], v91 offset:1536
    ds_read_b128 v[124:127], v91 offset:1792
    s_lshl_b32 s75, s74, 11
    s_lshl_b32 s76, s69, 8
    s_add_u32 s75, s75, s76
    s_add_u32 s75, s75, 4096
    v_mov_b32 v65, s72
    v_mov_b32 v67, s72
    s_waitcnt lgkmcnt(0)
    v_add_f32 v96, v96, v100
    v_add_f32 v97, v97, v101
    v_add_f32 v98, v98, v102
    v_add_f32 v99, v99, v103
    v_add_f32 v104, v104, v108
    v_add_f32 v105, v105, v109
    v_add_f32 v106, v106, v110
    v_add_f32 v107, v107, v111
    v_add_f32 v112, v112, v116
    v_add_f32 v113, v113, v117
    v_add_f32 v114, v114, v118
    v_add_f32 v115, v115, v119
    v_add_f32 v120, v120, v124
    v_add_f32 v121, v121, v125
    v_add_f32 v122, v122, v126
    v_add_f32 v123, v123, v127
    v_add_f32 v96, v96, v104
    v_add_f32 v97, v97, v105
    v_add_f32 v98, v98, v106
    v_add_f32 v99, v99, v107
    v_add_f32 v112, v112, v120
    v_add_f32 v113, v113, v121
    v_add_f32 v114, v114, v122
    v_add_f32 v115, v115, v123
    v_add_f32 v96, v96, v112
    v_add_f32 v97, v97, v113
    v_add_f32 v98, v98, v114
    v_add_f32 v99, v99, v115
    v_cvt_pk_bf16_f32 v64, v96, v97
    v_cvt_pk_bf16_f32 v66, v98, v99
    buffer_store_dwordx4 v[64:67], v91, s[60:63], s75 offen sc1
    s_mov_b64 exec, -1
L_qpub_done:
    s_add_u32 s15, s15, 3584
    buffer_load_dwordx2 v[196:197], v89, s[36:39], s15 offen
    s_add_u32 s80, s80, 8192
    s_and_b32 s80, s80, 0x3ffff
    buffer_load_dwordx4 a[88:91], v2, s[40:43], s80 offen offset:0 nt
    s_add_u32 s15, s15, 3584
    buffer_load_dwordx2 v[198:199], v89, s[36:39], s15 offen
    buffer_load_dwordx4 a[92:95], v2, s[40:43], s80 offen offset:256 nt
    s_add_u32 s15, s15, 3584
    buffer_load_dwordx2 v[200:201], v89, s[36:39], s15 offen
    s_add_u32 s80, s80, 8192
    s_and_b32 s80, s80, 0x3ffff
    buffer_load_dwordx4 a[96:99], v2, s[40:43], s80 offen offset:0 nt
    s_add_u32 s15, s15, 3584
    buffer_load_dwordx2 v[202:203], v89, s[36:39], s15 offen
    buffer_load_dwordx4 a[100:103], v2, s[40:43], s80 offen offset:256 nt
    s_add_u32 s15, s15, 3584
    buffer_load_dwordx2 v[204:205], v89, s[36:39], s15 offen
    s_add_u32 s80, s80, 8192
    s_and_b32 s80, s80, 0x3ffff
    buffer_load_dwordx4 a[104:107], v2, s[40:43], s80 offen offset:0 nt
    s_add_u32 s15, s15, 3584
    buffer_load_dwordx2 v[206:207], v89, s[36:39], s15 offen
    buffer_load_dwordx4 a[108:111], v2, s[40:43], s80 offen offset:256 nt
    s_add_u32 s15, s15, 3584
    buffer_load_dwordx2 v[208:209], v89, s[36:39], s15 offen
    s_add_u32 s80, s80, 8192
    s_and_b32 s80, s80, 0x3ffff
    buffer_load_dwordx4 a[112:115], v2, s[40:43], s80 offen offset:0 nt
    s_add_u32 s15, s15, 3584
    buffer_load_dwordx2 v[210:211], v89, s[36:39], s15 offen
    buffer_load_dwordx4 a[116:119], v2, s[40:43], s80 offen offset:256 nt
    buffer_load_dwordx4 v[248:251], v91, s[28:31], 0 offen
    buffer_load_dwordx4 v[252:255], v91, s[56:59], 0 offen
    s_mul_i32 s76, s73, 57344
    s_add_u32 s48, s12, s76
    s_addc_u32 s49, s13, 0
    s_mov_b32 s50, 57344
    s_mov_b32 s51, 0x20000
    s_mul_i32 s96, s71, 14336
    s_add_u32 s3, s96, 0
    s_add_u32 m0, s3, 12928
    s_nop 0
    buffer_load_dwordx4 v91, s[48:51], s3 offen offset:0 nt lds
    s_add_u32 s80, s80, 8192
    s_and_b32 s80, s80, 0x3ffff
    buffer_load_dwordx4 a[120:123], v2, s[40:43], s80 offen offset:0 nt
    buffer_load_dwordx4 v91, s[48:51], s3 offen offset:1024 nt lds
    buffer_load_dwordx4 a[124:127], v2, s[40:43], s80 offen offset:256 nt
    buffer_load_dwordx4 v91, s[48:51], s3 offen offset:2048 nt lds
    s_add_u32 s80, s80, 8192
    s_and_b32 s80, s80, 0x3ffff
    buffer_load_dwordx4 a[128:131], v2, s[40:43], s80 offen offset:0 nt
    buffer_load_dwordx4 v91, s[48:51], s3 offen offset:3072 nt lds
    buffer_load_dwordx4 a[132:135], v2, s[40:43], s80 offen offset:256 nt
    s_add_u32 s3, s96, 4096
    s_add_u32 m0, s3, 12928
    s_nop 0
    buffer_load_dwordx4 v91, s[48:51], s3 offen offset:0 nt lds
    s_add_u32 s80, s80, 8192
    s_and_b32 s80, s80, 0x3ffff
    buffer_load_dwordx4 a[136:139], v2, s[40:43], s80 offen offset:0 nt
    buffer_load_dwordx4 v91, s[48:51], s3 offen offset:1024 nt lds
    buffer_load_dwordx4 a[140:143], v2, s[40:43], s80 offen offset:256 nt
    v_perm_b32 v226, v212, v212, s83
    v_and_b32 v236, v226, v224
    v_and_b32 v237, v226, v225
    v_perm_b32 v226, v212, v212, s84
    v_and_b32 v238, v226, v224
    v_and_b32 v239, v226, v225
    s_waitcnt vmcnt(31)
    v_mfma_f32_16x16x16_bf16 v[244:247], v[236:237], v[184:185], 0
    v_perm_b32 v226, v213, v213, s83
    v_and_b32 v236, v226, v224
    v_and_b32 v237, v226, v225
    v_mfma_f32_16x16x16_bf16 v[244:247], v[238:239], v[186:187], v[244:247]
    v_perm_b32 v226, v213, v213, s84
    v_and_b32 v238, v226, v224
    v_and_b32 v239, v226, v225
    v_mfma_f32_16x16x16_bf16 v[244:247], v[236:237], v[188:189], v[244:247]
    v_perm_b32 v226, v214, v214, s83
    v_and_b32 v236, v226, v224
    v_and_b32 v237, v226, v225
    v_mfma_f32_16x16x16_bf16 v[244:247], v[238:239], v[190:191], v[244:247]
    v_perm_b32 v226, v214, v214, s84
    v_and_b32 v238, v226, v224
    v_and_b32 v239, v226, v225
    v_mfma_f32_16x16x16_bf16 v[244:247], v[236:237], v[192:193], v[244:247]
    v_perm_b32 v226, v215, v215, s83
    v_and_b32 v236, v226, v224
    v_and_b32 v237, v226, v225
    v_mfma_f32_16x16x16_bf16 v[244:247], v[238:239], v[194:195], v[244:247]
    v_perm_b32 v226, v215, v215, s84
    v_and_b32 v238, v226, v224
    v_and_b32 v239, v226, v225
    s_waitcnt vmcnt(17)
    v_mfma_f32_16x16x16_bf16 v[244:247], v[236:237], v[196:197], v[244:247]
    v_perm_b32 v226, v216, v216, s83
    v_and_b32 v236, v226, v224
    v_and_b32 v237, v226, v225
    v_mfma_f32_16x16x16_bf16 v[244:247], v[238:239], v[198:199], v[244:247]
    v_perm_b32 v226, v216, v216, s84
    v_and_b32 v238, v226, v224
    v_and_b32 v239, v226, v225
    v_mfma_f32_16x16x16_bf16 v[244:247], v[236:237], v[200:201], v[244:247]
    v_perm_b32 v226, v217, v217, s83
    v_and_b32 v236, v226, v224
    v_and_b32 v237, v226, v225
    v_mfma_f32_16x16x16_bf16 v[244:247], v[238:239], v[202:203], v[244:247]
    v_perm_b32 v226, v217, v217, s84
    v_and_b32 v238, v226, v224
    v_and_b32 v239, v226, v225
    v_mfma_f32_16x16x16_bf16 v[244:247], v[236:237], v[204:205], v[244:247]
    v_perm_b32 v226, v218, v218, s83
    v_and_b32 v236, v226, v224
    v_and_b32 v237, v226, v225
    v_mfma_f32_16x16x16_bf16 v[244:247], v[238:239], v[206:207], v[244:247]
    v_perm_b32 v226, v218, v218, s84
    v_and_b32 v238, v226, v224
    v_and_b32 v239, v226, v225
    v_mfma_f32_16x16x16_bf16 v[244:247], v[236:237], v[208:209], v[244:247]
    s_waitcnt vmcnt(15)
    v_mfma_f32_16x16x16_bf16 v[244:247], v[238:239], v[210:211], v[244:247]
    v_lshrrev_b32 v93, 5, v1
    s_lshl_b32 s75, s71, 1
    v_add_u32 v93, s75, v93
    v_lshlrev_b32 v93, 7, v93
    v_and_b32 v94, 7, v1
    v_lshl_add_u32 v93, v94, 4, v93
    s_mov_b32 exec_lo, 0x000000ff
    s_mov_b32 exec_hi, 0x0000ff00
    ds_write_b128 v93, v[244:247] offset:2048
    s_mov_b64 exec, -1
    s_waitcnt vmcnt(12)
    v_lshlrev_b32 v105, 16, v248
    v_and_b32 v106, 0xffff0000, v248
    v_lshlrev_b32 v107, 16, v252
    v_and_b32 v108, 0xffff0000, v252
    v_mul_f32 v105, v105, v107
    v_mul_f32 v106, v106, v108
    v_cvt_pk_bf16_f32 v105, v105, v106
    v_and_b32 v106, 0xffff0000, v105
    v_lshlrev_b32 v105, 16, v105
    v_add_f32 v104, v105, v106
    v_lshlrev_b32 v105, 16, v249
    v_and_b32 v106, 0xffff0000, v249
    v_lshlrev_b32 v107, 16, v253
    v_and_b32 v108, 0xffff0000, v253
    v_mul_f32 v105, v105, v107
    v_mul_f32 v106, v106, v108
    v_cvt_pk_bf16_f32 v105, v105, v106
    v_and_b32 v106, 0xffff0000, v105
    v_lshlrev_b32 v105, 16, v105
    v_add_f32 v104, v104, v105
    v_add_f32 v104, v104, v106
    v_lshlrev_b32 v105, 16, v250
    v_and_b32 v106, 0xffff0000, v250
    v_lshlrev_b32 v107, 16, v254
    v_and_b32 v108, 0xffff0000, v254
    v_mul_f32 v105, v105, v107
    v_mul_f32 v106, v106, v108
    v_cvt_pk_bf16_f32 v105, v105, v106
    v_and_b32 v106, 0xffff0000, v105
    v_lshlrev_b32 v105, 16, v105
    v_add_f32 v104, v104, v105
    v_add_f32 v104, v104, v106
    v_lshlrev_b32 v105, 16, v251
    v_and_b32 v106, 0xffff0000, v251
    v_lshlrev_b32 v107, 16, v255
    v_and_b32 v108, 0xffff0000, v255
    v_mul_f32 v105, v105, v107
    v_mul_f32 v106, v106, v108
    v_cvt_pk_bf16_f32 v105, v105, v106
    v_and_b32 v106, 0xffff0000, v105
    v_lshlrev_b32 v105, 16, v105
    v_add_f32 v104, v104, v105
    v_add_f32 v104, v104, v106
    s_nop 1
    v_add_f32_dpp v104, v104, v104 row_ror:8 row_mask:0xf bank_mask:0xf
    s_nop 1
    v_add_f32_dpp v104, v104, v104 row_ror:4 row_mask:0xf bank_mask:0xf
    s_nop 1
    v_add_f32_dpp v104, v104, v104 row_ror:2 row_mask:0xf bank_mask:0xf
    s_nop 1
    v_add_f32_dpp v104, v104, v104 row_ror:1 row_mask:0xf bank_mask:0xf
    s_nop 0
    v_readlane_b32 s75, v104, 0
    v_readlane_b32 s76, v104, 16
    v_readlane_b32 s77, v104, 32
    v_readlane_b32 s78, v104, 48
    v_mov_b32 v104, s75
    v_add_f32 v104, s76, v104
    v_add_f32 v104, s77, v104
    v_add_f32 v104, s78, v104
    v_cvt_pk_bf16_f32 v104, v104, v104
    v_and_b32 v104, 0xffff0000, v104
    v_mul_f32 v104, 0xbfb8aa3b, v104
    v_exp_f32 v104, v104
    s_nop 0
    v_add_f32 v104, 1.0, v104
    v_rcp_f32 v104, v104
    s_nop 0
    v_cvt_pk_bf16_f32 v104, v104, v104
    v_and_b32 v104, 0xffff0000, v104
    v_sub_f32 v105, 1.0, v104
    v_cvt_pk_bf16_f32 v105, v105, v105
    v_and_b32 v105, 0xffff0000, v105
    v_readfirstlane_b32 s94, v104
    v_readfirstlane_b32 s95, v105
    s_cmp_lg_u32 s71, 0
    s_cbranch_scc1 L_nopoll
    s_lshl_b32 s79, s74, 11
    s_add_u32 s79, s79, 4096
    buffer_load_dwordx4 v[96:99], v91, s[60:63], s79 offen sc1
    buffer_load_dwordx4 v[100:103], v91, s[60:63], s79 offen offset:1024 sc1
L_nopoll:
    buffer_load_dwordx4 v91, s[48:51], s3 offen offset:2048 nt lds
    s_add_u32 s80, s80, 8192
    s_and_b32 s80, s80, 0x3ffff
    buffer_load_dwordx4 a[144:147], v2, s[40:43], s80 offen offset:0 nt
    buffer_load_dwordx4 v91, s[48:51], s3 offen offset:3072 nt lds
    buffer_load_dwordx4 a[148:151], v2, s[40:43], s80 offen offset:256 nt
    s_add_u32 s3, s96, 8192
    s_add_u32 m0, s3, 12928
    s_nop 0
    buffer_load_dwordx4 v91, s[48:51], s3 offen offset:0 nt lds
    s_add_u32 s80, s80, 8192
    s_and_b32 s80, s80, 0x3ffff
    buffer_load_dwordx4 a[152:155], v2, s[40:43], s80 offen offset:0 nt
    s_lshl_b32 s75, s74, 15
    s_lshl_b32 s76, s69, 12
    s_add_u32 s75, s75, s76
    s_lshl_b32 s76, s71, 10
    s_add_u32 s75, s75, s76
    s_add_u32 s75, s75, 262144
    buffer_load_dwordx4 v[80:83], v91, s[60:63], s75 offen sc1
    s_lshl_b32 s75, s74, 10
    s_lshl_b32 s76, s71, 8
    s_add_u32 s75, s75, s76
    s_add_u32 s75, s75, 131072
    v_lshrrev_b32 v94, 5, v1
    v_lshlrev_b32 v94, 7, v94
    buffer_load_dword v84, v94, s[60:63], s75 offen sc1
    s_mul_i32 s75, s70, 229376
    s_lshl_b32 s76, s73, 12
    s_add_u32 s75, s75, s76
    s_lshl_b32 s76, s71, 10
    s_add_u32 s75, s75, s76
    s_add_u32 s75, s75, 2097152
    buffer_load_dwordx4 v[80:83], v91, s[60:63], s75 offen sc1
    buffer_load_dwordx4 v91, s[48:51], s3 offen offset:1024 nt lds
    buffer_load_dwordx4 a[156:159], v2, s[40:43], s80 offen offset:256 nt
    buffer_load_dwordx4 v91, s[48:51], s3 offen offset:2048 nt lds
    s_add_u32 s80, s80, 8192
    s_and_b32 s80, s80, 0x3ffff
    buffer_load_dwordx4 a[160:163], v2, s[40:43], s80 offen offset:0 nt
    buffer_load_dwordx4 v91, s[48:51], s3 offen offset:3072 nt lds
    buffer_load_dwordx4 a[164:167], v2, s[40:43], s80 offen offset:256 nt
    s_add_u32 s3, s96, 12288
    s_add_u32 m0, s3, 12928
    s_nop 0
    buffer_load_dwordx4 v91, s[48:51], s3 offen offset:0 nt lds
    s_add_u32 s80, s80, 8192
    s_and_b32 s80, s80, 0x3ffff
    buffer_load_dwordx4 a[168:171], v2, s[40:43], s80 offen offset:0 nt
    s_cmp_lg_u32 s71, 0
    s_cbranch_scc1 L_qwait_done
    s_waitcnt vmcnt(17)
    s_mov_b32 s85, 100000
L_qcheck:
    v_cmpx_eq_u32 vcc, s72, v97
    v_cmpx_eq_u32 vcc, s72, v99
    v_cmpx_eq_u32 vcc, s72, v101
    v_cmpx_eq_u32 vcc, s72, v103
    s_nop 4
    s_cmp_eq_u64 exec, -1
    s_mov_b64 exec, -1
    s_cbranch_scc1 L_qok
    s_sub_u32 s85, s85, 1
    s_cbranch_scc1 L_qok
    s_sleep 2
    buffer_load_dwordx4 v[96:99], v91, s[60:63], s79 offen sc1
    buffer_load_dwordx4 v[100:103], v91, s[60:63], s79 offen offset:1024 sc1
    s_waitcnt vmcnt(0)
    s_branch L_qcheck
L_qok:
    v_lshlrev_b32 v93, 3, v1
    v_add_u32 v93, 3072, v93
    ds_write2_b32 v93, v96, v98 offset0:0 offset1:1
    ds_write2_b32 v93, v100, v102 offset0:128 offset1:129
L_qwait_done:
    s_waitcnt lgkmcnt(0)
    s_barrier
    v_bfe_u32 v93, v1, 2, 1
    v_lshlrev_b32 v93, 9, v93
    v_lshrrev_b32 v94, 4, v1
    v_lshl_add_u32 v93, v94, 6, v93
    v_and_b32 v94, 3, v1
    v_lshl_add_u32 v93, v94, 4, v93
    ds_read_b128 v[8:11], v93 offset:3072
    ds_read_b128 v[12:15], v93 offset:3328
    s_cmp_lg_u32 s71, 1
    s_cbranch_scc1 L_h_done
    s_mov_b64 exec, 0xff
    ds_read_b128 v[96:99], v91 offset:2048
    ds_read_b128 v[100:103], v91 offset:2176
    ds_read_b128 v[104:107], v91 offset:2304
    ds_read_b128 v[108:111], v91 offset:2432
    ds_read_b128 v[112:115], v91 offset:2560
    ds_read_b128 v[116:119], v91 offset:2688
    ds_read_b128 v[120:123], v91 offset:2816
    ds_read_b128 v[124:127], v91 offset:2944
    s_waitcnt lgkmcnt(0)
    v_add_f32 v96, v96, v100
    v_add_f32 v97, v97, v101
    v_add_f32 v98, v98, v102
    v_add_f32 v99, v99, v103
    v_add_f32 v104, v104, v108
    v_add_f32 v105, v105, v109
    v_add_f32 v106, v106, v110
    v_add_f32 v107, v107, v111
    v_add_f32 v112, v112, v116
    v_add_f32 v113, v113, v117
    v_add_f32 v114, v114, v118
    v_add_f32 v115, v115, v119
    v_add_f32 v120, v120, v124
    v_add_f32 v121, v121, v125
    v_add_f32 v122, v122, v126
    v_add_f32 v123, v123, v127
    v_add_f32 v96, v96, v104
    v_add_f32 v97, v97, v105
    v_add_f32 v98, v98, v106
    v_add_f32 v99, v99, v107
    v_add_f32 v112, v112, v120
    v_add_f32 v113, v113, v121
    v_add_f32 v114, v114, v122
    v_add_f32 v115, v115, v123
    v_add_f32 v96, v96, v112
    v_add_f32 v97, v97, v113
    v_add_f32 v98, v98, v114
    v_add_f32 v99, v99, v115
    v_max_f32 v96, 0, v96
    v_max_f32 v97, 0, v97
    v_max_f32 v98, 0, v98
    v_max_f32 v99, 0, v99
    v_cvt_pk_bf16_f32 v100, v96, v97
    v_cvt_pk_bf16_f32 v101, v98, v99
    v_lshlrev_b32 v93, 3, v1
    ds_write_b64 v93, v[100:101] offset:4096
    s_mov_b64 exec, -1
L_h_done:
    s_waitcnt lgkmcnt(0)
    s_waitcnt vmcnt(63)
    v_mfma_f32_16x16x32_bf16 v[64:67], a[0:3], v[8:11], 0
    v_mfma_f32_16x16x32_bf16 v[64:67], a[4:7], v[12:15], v[64:67]
    buffer_load_dwordx4 v91, s[48:51], s3 offen offset:1024 nt lds
    buffer_load_dwordx4 a[172:175], v2, s[40:43], s80 offen offset:256 nt
    s_waitcnt vmcnt(63)
    v_mfma_f32_16x16x32_bf16 v[68:71], a[8:11], v[8:11], 0
    v_mfma_f32_16x16x32_bf16 v[68:71], a[12:15], v[12:15], v[68:71]
    s_nop 2
    v_mov_b32_dpp v32, v64 quad_perm:[0,0,0,0] row_mask:0xf bank_mask:0xf
    v_add_f32_dpp v32, v65, v32 quad_perm:[1,1,1,1] row_mask:0xf bank_mask:0xf
    v_add_f32_dpp v32, v66, v32 quad_perm:[2,2,2,2] row_mask:0xf bank_mask:0xf
    v_add_f32_dpp v32, v67, v32 quad_perm:[3,3,3,3] row_mask:0xf bank_mask:0xf
    v_cvt_pk_bf16_f32 v32, v32, v32
    v_and_b32 v32, 0xffff0000, v32
    v_mov_b32 v92, v32
    s_mul_i32 s97, s71, 7168
    s_add_u32 s3, s97, 0
    s_add_u32 m0, s3, 70272
    s_nop 0
    buffer_load_dwordx4 v91, s[52:55], s3 offen offset:0 nt lds
    s_add_u32 s80, s80, 8192
    s_and_b32 s80, s80, 0x3ffff
    buffer_load_dwordx4 a[176:179], v2, s[40:43], s80 offen offset:0 nt
    s_waitcnt vmcnt(63)
    v_mfma_f32_16x16x32_bf16 v[72:75], a[16:19], v[8:11], 0
    v_mfma_f32_16x16x32_bf16 v[72:75], a[20:23], v[12:15], v[72:75]
    v_mov_b32_dpp v33, v68 quad_perm:[0,0,0,0] row_mask:0xf bank_mask:0xf
    v_add_f32_dpp v33, v69, v33 quad_perm:[1,1,1,1] row_mask:0xf bank_mask:0xf
    v_add_f32_dpp v33, v70, v33 quad_perm:[2,2,2,2] row_mask:0xf bank_mask:0xf
    v_add_f32_dpp v33, v71, v33 quad_perm:[3,3,3,3] row_mask:0xf bank_mask:0xf
    v_cvt_pk_bf16_f32 v33, v33, v33
    v_and_b32 v33, 0xffff0000, v33
    v_max_f32 v92, v92, v33
    buffer_load_dwordx4 v91, s[52:55], s3 offen offset:1024 nt lds
    buffer_load_dwordx4 a[180:183], v2, s[40:43], s80 offen offset:256 nt
    s_waitcnt vmcnt(63)
    v_mfma_f32_16x16x32_bf16 v[76:79], a[24:27], v[8:11], 0
    v_mfma_f32_16x16x32_bf16 v[76:79], a[28:31], v[12:15], v[76:79]
    v_mov_b32_dpp v34, v72 quad_perm:[0,0,0,0] row_mask:0xf bank_mask:0xf
    v_add_f32_dpp v34, v73, v34 quad_perm:[1,1,1,1] row_mask:0xf bank_mask:0xf
    v_add_f32_dpp v34, v74, v34 quad_perm:[2,2,2,2] row_mask:0xf bank_mask:0xf
    v_add_f32_dpp v34, v75, v34 quad_perm:[3,3,3,3] row_mask:0xf bank_mask:0xf
    v_cvt_pk_bf16_f32 v34, v34, v34
    v_and_b32 v34, 0xffff0000, v34
    v_max_f32 v92, v92, v34
    buffer_load_dwordx4 v91, s[52:55], s3 offen offset:2048 nt lds
    s_add_u32 s80, s80, 8192
    s_and_b32 s80, s80, 0x3ffff
    buffer_load_dwordx4 a[184:187], v2, s[40:43], s80 offen offset:0 nt
    s_waitcnt vmcnt(63)
    v_mfma_f32_16x16x32_bf16 v[64:67], a[32:35], v[8:11], 0
    v_mfma_f32_16x16x32_bf16 v[64:67], a[36:39], v[12:15], v[64:67]
    v_mov_b32_dpp v35, v76 quad_perm:[0,0,0,0] row_mask:0xf bank_mask:0xf
    v_add_f32_dpp v35, v77, v35 quad_perm:[1,1,1,1] row_mask:0xf bank_mask:0xf
    v_add_f32_dpp v35, v78, v35 quad_perm:[2,2,2,2] row_mask:0xf bank_mask:0xf
    v_add_f32_dpp v35, v79, v35 quad_perm:[3,3,3,3] row_mask:0xf bank_mask:0xf
    v_cvt_pk_bf16_f32 v35, v35, v35
    v_and_b32 v35, 0xffff0000, v35
    v_max_f32 v92, v92, v35
    buffer_load_dwordx4 v91, s[52:55], s3 offen offset:3072 nt lds
    buffer_load_dwordx4 a[188:191], v2, s[40:43], s80 offen offset:256 nt
    s_waitcnt vmcnt(63)
    v_mfma_f32_16x16x32_bf16 v[68:71], a[40:43], v[8:11], 0
    v_mfma_f32_16x16x32_bf16 v[68:71], a[44:47], v[12:15], v[68:71]
    v_mov_b32_dpp v36, v64 quad_perm:[0,0,0,0] row_mask:0xf bank_mask:0xf
    v_add_f32_dpp v36, v65, v36 quad_perm:[1,1,1,1] row_mask:0xf bank_mask:0xf
    v_add_f32_dpp v36, v66, v36 quad_perm:[2,2,2,2] row_mask:0xf bank_mask:0xf
    v_add_f32_dpp v36, v67, v36 quad_perm:[3,3,3,3] row_mask:0xf bank_mask:0xf
    v_cvt_pk_bf16_f32 v36, v36, v36
    v_and_b32 v36, 0xffff0000, v36
    v_max_f32 v92, v92, v36
    s_add_u32 s3, s97, 4096
    s_add_u32 m0, s3, 70272
    s_nop 0
    buffer_load_dwordx4 v91, s[52:55], s3 offen offset:0 nt lds
    s_add_u32 s80, s80, 8192
    s_and_b32 s80, s80, 0x3ffff
    buffer_load_dwordx4 a[192:195], v2, s[40:43], s80 offen offset:0 nt
    s_waitcnt vmcnt(63)
    v_mfma_f32_16x16x32_bf16 v[72:75], a[48:51], v[8:11], 0
    v_mfma_f32_16x16x32_bf16 v[72:75], a[52:55], v[12:15], v[72:75]
    v_mov_b32_dpp v37, v68 quad_perm:[0,0,0,0] row_mask:0xf bank_mask:0xf
    v_add_f32_dpp v37, v69, v37 quad_perm:[1,1,1,1] row_mask:0xf bank_mask:0xf
    v_add_f32_dpp v37, v70, v37 quad_perm:[2,2,2,2] row_mask:0xf bank_mask:0xf
    v_add_f32_dpp v37, v71, v37 quad_perm:[3,3,3,3] row_mask:0xf bank_mask:0xf
    v_cvt_pk_bf16_f32 v37, v37, v37
    v_and_b32 v37, 0xffff0000, v37
    v_max_f32 v92, v92, v37
    buffer_load_dwordx4 v91, s[52:55], s3 offen offset:1024 nt lds
    buffer_load_dwordx4 a[196:199], v2, s[40:43], s80 offen offset:256 nt
    s_waitcnt vmcnt(63)
    v_mfma_f32_16x16x32_bf16 v[76:79], a[56:59], v[8:11], 0
    v_mfma_f32_16x16x32_bf16 v[76:79], a[60:63], v[12:15], v[76:79]
    v_mov_b32_dpp v38, v72 quad_perm:[0,0,0,0] row_mask:0xf bank_mask:0xf
    v_add_f32_dpp v38, v73, v38 quad_perm:[1,1,1,1] row_mask:0xf bank_mask:0xf
    v_add_f32_dpp v38, v74, v38 quad_perm:[2,2,2,2] row_mask:0xf bank_mask:0xf
    v_add_f32_dpp v38, v75, v38 quad_perm:[3,3,3,3] row_mask:0xf bank_mask:0xf
    v_cvt_pk_bf16_f32 v38, v38, v38
    v_and_b32 v38, 0xffff0000, v38
    v_max_f32 v92, v92, v38
    buffer_load_dwordx4 v91, s[52:55], s3 offen offset:2048 nt lds
    s_add_u32 s80, s80, 8192
    s_and_b32 s80, s80, 0x3ffff
    buffer_load_dwordx4 a[200:203], v2, s[40:43], s80 offen offset:0 nt
    s_waitcnt vmcnt(63)
    v_mfma_f32_16x16x32_bf16 v[64:67], a[64:67], v[8:11], 0
    v_mfma_f32_16x16x32_bf16 v[64:67], a[68:71], v[12:15], v[64:67]
    v_mov_b32_dpp v39, v76 quad_perm:[0,0,0,0] row_mask:0xf bank_mask:0xf
    v_add_f32_dpp v39, v77, v39 quad_perm:[1,1,1,1] row_mask:0xf bank_mask:0xf
    v_add_f32_dpp v39, v78, v39 quad_perm:[2,2,2,2] row_mask:0xf bank_mask:0xf
    v_add_f32_dpp v39, v79, v39 quad_perm:[3,3,3,3] row_mask:0xf bank_mask:0xf
    v_cvt_pk_bf16_f32 v39, v39, v39
    v_and_b32 v39, 0xffff0000, v39
    v_max_f32 v92, v92, v39
    buffer_load_dwordx4 a[204:207], v2, s[40:43], s80 offen offset:256 nt
    s_waitcnt vmcnt(63)
    v_mfma_f32_16x16x32_bf16 v[68:71], a[72:75], v[8:11], 0
    v_mfma_f32_16x16x32_bf16 v[68:71], a[76:79], v[12:15], v[68:71]
    v_mov_b32_dpp v40, v64 quad_perm:[0,0,0,0] row_mask:0xf bank_mask:0xf
    v_add_f32_dpp v40, v65, v40 quad_perm:[1,1,1,1] row_mask:0xf bank_mask:0xf
    v_add_f32_dpp v40, v66, v40 quad_perm:[2,2,2,2] row_mask:0xf bank_mask:0xf
    v_add_f32_dpp v40, v67, v40 quad_perm:[3,3,3,3] row_mask:0xf bank_mask:0xf
    v_cvt_pk_bf16_f32 v40, v40, v40
    v_and_b32 v40, 0xffff0000, v40
    v_max_f32 v92, v92, v40
    s_add_u32 s80, s80, 8192
    s_and_b32 s80, s80, 0x3ffff
    buffer_load_dwordx4 a[208:211], v2, s[40:43], s80 offen offset:0 nt
    s_waitcnt vmcnt(63)
    v_mfma_f32_16x16x32_bf16 v[72:75], a[80:83], v[8:11], 0
    v_mfma_f32_16x16x32_bf16 v[72:75], a[84:87], v[12:15], v[72:75]
    v_mov_b32_dpp v41, v68 quad_perm:[0,0,0,0] row_mask:0xf bank_mask:0xf
    v_add_f32_dpp v41, v69, v41 quad_perm:[1,1,1,1] row_mask:0xf bank_mask:0xf
    v_add_f32_dpp v41, v70, v41 quad_perm:[2,2,2,2] row_mask:0xf bank_mask:0xf
    v_add_f32_dpp v41, v71, v41 quad_perm:[3,3,3,3] row_mask:0xf bank_mask:0xf
    v_cvt_pk_bf16_f32 v41, v41, v41
    v_and_b32 v41, 0xffff0000, v41
    v_max_f32 v92, v92, v41
    buffer_load_dwordx4 a[212:215], v2, s[40:43], s80 offen offset:256 nt
    s_waitcnt vmcnt(62)
    v_mfma_f32_16x16x32_bf16 v[76:79], a[88:91], v[8:11], 0
    v_mfma_f32_16x16x32_bf16 v[76:79], a[92:95], v[12:15], v[76:79]
    v_mov_b32_dpp v42, v72 quad_perm:[0,0,0,0] row_mask:0xf bank_mask:0xf
    v_add_f32_dpp v42, v73, v42 quad_perm:[1,1,1,1] row_mask:0xf bank_mask:0xf
    v_add_f32_dpp v42, v74, v42 quad_perm:[2,2,2,2] row_mask:0xf bank_mask:0xf
    v_add_f32_dpp v42, v75, v42 quad_perm:[3,3,3,3] row_mask:0xf bank_mask:0xf
    v_cvt_pk_bf16_f32 v42, v42, v42
    v_and_b32 v42, 0xffff0000, v42
    v_max_f32 v92, v92, v42
    s_add_u32 s80, s80, 8192
    s_and_b32 s80, s80, 0x3ffff
    buffer_load_dwordx4 a[216:219], v2, s[40:43], s80 offen offset:0 nt
    s_waitcnt vmcnt(59)
    v_mfma_f32_16x16x32_bf16 v[64:67], a[96:99], v[8:11], 0
    v_mfma_f32_16x16x32_bf16 v[64:67], a[100:103], v[12:15], v[64:67]
    v_mov_b32_dpp v43, v76 quad_perm:[0,0,0,0] row_mask:0xf bank_mask:0xf
    v_add_f32_dpp v43, v77, v43 quad_perm:[1,1,1,1] row_mask:0xf bank_mask:0xf
    v_add_f32_dpp v43, v78, v43 quad_perm:[2,2,2,2] row_mask:0xf bank_mask:0xf
    v_add_f32_dpp v43, v79, v43 quad_perm:[3,3,3,3] row_mask:0xf bank_mask:0xf
    v_cvt_pk_bf16_f32 v43, v43, v43
    v_and_b32 v43, 0xffff0000, v43
    v_max_f32 v92, v92, v43
    buffer_load_dwordx4 a[220:223], v2, s[40:43], s80 offen offset:256 nt
    s_waitcnt vmcnt(56)
    v_mfma_f32_16x16x32_bf16 v[68:71], a[104:107], v[8:11], 0
    v_mfma_f32_16x16x32_bf16 v[68:71], a[108:111], v[12:15], v[68:71]
    v_mov_b32_dpp v44, v64 quad_perm:[0,0,0,0] row_mask:0xf bank_mask:0xf
    v_add_f32_dpp v44, v65, v44 quad_perm:[1,1,1,1] row_mask:0xf bank_mask:0xf
    v_add_f32_dpp v44, v66, v44 quad_perm:[2,2,2,2] row_mask:0xf bank_mask:0xf
    v_add_f32_dpp v44, v67, v44 quad_perm:[3,3,3,3] row_mask:0xf bank_mask:0xf
    v_cvt_pk_bf16_f32 v44, v44, v44
    v_and_b32 v44, 0xffff0000, v44
    v_max_f32 v92, v92, v44
    s_add_u32 s80, s80, 8192
    s_and_b32 s80, s80, 0x3ffff
    buffer_load_dwordx4 a[224:227], v2, s[40:43], s80 offen offset:0 nt
    buffer_load_dwordx4 a[228:231], v2, s[40:43], s80 offen offset:256 nt
    s_waitcnt vmcnt(54)
    v_mfma_f32_16x16x32_bf16 v[72:75], a[112:115], v[8:11], 0
    v_mfma_f32_16x16x32_bf16 v[72:75], a[116:119], v[12:15], v[72:75]
    v_mov_b32_dpp v45, v68 quad_perm:[0,0,0,0] row_mask:0xf bank_mask:0xf
    v_add_f32_dpp v45, v69, v45 quad_perm:[1,1,1,1] row_mask:0xf bank_mask:0xf
    v_add_f32_dpp v45, v70, v45 quad_perm:[2,2,2,2] row_mask:0xf bank_mask:0xf
    v_add_f32_dpp v45, v71, v45 quad_perm:[3,3,3,3] row_mask:0xf bank_mask:0xf
    v_cvt_pk_bf16_f32 v45, v45, v45
    v_and_b32 v45, 0xffff0000, v45
    v_max_f32 v92, v92, v45
    s_add_u32 s80, s80, 8192
    s_and_b32 s80, s80, 0x3ffff
    buffer_load_dwordx4 a[232:235], v2, s[40:43], s80 offen offset:0 nt
    buffer_load_dwordx4 a[236:239], v2, s[40:43], s80 offen offset:256 nt
    s_waitcnt vmcnt(50)
    v_mfma_f32_16x16x32_bf16 v[76:79], a[120:123], v[8:11], 0
    v_mfma_f32_16x16x32_bf16 v[76:79], a[124:127], v[12:15], v[76:79]
    v_mov_b32_dpp v46, v72 quad_perm:[0,0,0,0] row_mask:0xf bank_mask:0xf
    v_add_f32_dpp v46, v73, v46 quad_perm:[1,1,1,1] row_mask:0xf bank_mask:0xf
    v_add_f32_dpp v46, v74, v46 quad_perm:[2,2,2,2] row_mask:0xf bank_mask:0xf
    v_add_f32_dpp v46, v75, v46 quad_perm:[3,3,3,3] row_mask:0xf bank_mask:0xf
    v_cvt_pk_bf16_f32 v46, v46, v46
    v_and_b32 v46, 0xffff0000, v46
    v_max_f32 v92, v92, v46
    s_add_u32 s80, s80, 8192
    s_and_b32 s80, s80, 0x3ffff
    buffer_load_dwordx4 a[240:243], v2, s[40:43], s80 offen offset:0 nt
    buffer_load_dwordx4 a[244:247], v2, s[40:43], s80 offen offset:256 nt
    s_waitcnt vmcnt(48)
    v_mfma_f32_16x16x32_bf16 v[64:67], a[128:131], v[8:11], 0
    v_mfma_f32_16x16x32_bf16 v[64:67], a[132:135], v[12:15], v[64:67]
    v_mov_b32_dpp v47, v76 quad_perm:[0,0,0,0] row_mask:0xf bank_mask:0xf
    v_add_f32_dpp v47, v77, v47 quad_perm:[1,1,1,1] row_mask:0xf bank_mask:0xf
    v_add_f32_dpp v47, v78, v47 quad_perm:[2,2,2,2] row_mask:0xf bank_mask:0xf
    v_add_f32_dpp v47, v79, v47 quad_perm:[3,3,3,3] row_mask:0xf bank_mask:0xf
    v_cvt_pk_bf16_f32 v47, v47, v47
    v_and_b32 v47, 0xffff0000, v47
    v_max_f32 v92, v92, v47
    s_add_u32 s80, s80, 8192
    s_and_b32 s80, s80, 0x3ffff
    buffer_load_dwordx4 a[248:251], v2, s[40:43], s80 offen offset:0 nt
    buffer_load_dwordx4 a[252:255], v2, s[40:43], s80 offen offset:256 nt
    s_waitcnt vmcnt(46)
    v_mfma_f32_16x16x32_bf16 v[68:71], a[136:139], v[8:11], 0
    v_mfma_f32_16x16x32_bf16 v[68:71], a[140:143], v[12:15], v[68:71]
    v_mov_b32_dpp v48, v64 quad_perm:[0,0,0,0] row_mask:0xf bank_mask:0xf
    v_add_f32_dpp v48, v65, v48 quad_perm:[1,1,1,1] row_mask:0xf bank_mask:0xf
    v_add_f32_dpp v48, v66, v48 quad_perm:[2,2,2,2] row_mask:0xf bank_mask:0xf
    v_add_f32_dpp v48, v67, v48 quad_perm:[3,3,3,3] row_mask:0xf bank_mask:0xf
    v_cvt_pk_bf16_f32 v48, v48, v48
    v_and_b32 v48, 0xffff0000, v48
    v_max_f32 v92, v92, v48
    s_lshl_b32 s81, s68, 2
    s_add_u32 s81, s81, s70
    s_lshl_b32 s81, s81, 13
    buffer_load_dwordx4 v[128:131], v3, s[44:47], s81 offen offset:0 nt
    buffer_load_dwordx4 v[132:135], v3, s[44:47], s81 offen offset:256 nt
    s_waitcnt vmcnt(44)
    v_mfma_f32_16x16x32_bf16 v[72:75], a[144:147], v[8:11], 0
    v_mfma_f32_16x16x32_bf16 v[72:75], a[148:151], v[12:15], v[72:75]
    v_mov_b32_dpp v49, v68 quad_perm:[0,0,0,0] row_mask:0xf bank_mask:0xf
    v_add_f32_dpp v49, v69, v49 quad_perm:[1,1,1,1] row_mask:0xf bank_mask:0xf
    v_add_f32_dpp v49, v70, v49 quad_perm:[2,2,2,2] row_mask:0xf bank_mask:0xf
    v_add_f32_dpp v49, v71, v49 quad_perm:[3,3,3,3] row_mask:0xf bank_mask:0xf
    v_cvt_pk_bf16_f32 v49, v49, v49
    v_and_b32 v49, 0xffff0000, v49
    v_max_f32 v92, v92, v49
    s_add_u32 s81, s81, 8192
    s_and_b32 s81, s81, 0x3ffff
    buffer_load_dwordx4 v[136:139], v3, s[44:47], s81 offen offset:0 nt
    buffer_load_dwordx4 v[140:143], v3, s[44:47], s81 offen offset:256 nt
    s_waitcnt vmcnt(39)
    v_mfma_f32_16x16x32_bf16 v[76:79], a[152:155], v[8:11], 0
    v_mfma_f32_16x16x32_bf16 v[76:79], a[156:159], v[12:15], v[76:79]
    v_mov_b32_dpp v50, v72 quad_perm:[0,0,0,0] row_mask:0xf bank_mask:0xf
    v_add_f32_dpp v50, v73, v50 quad_perm:[1,1,1,1] row_mask:0xf bank_mask:0xf
    v_add_f32_dpp v50, v74, v50 quad_perm:[2,2,2,2] row_mask:0xf bank_mask:0xf
    v_add_f32_dpp v50, v75, v50 quad_perm:[3,3,3,3] row_mask:0xf bank_mask:0xf
    v_cvt_pk_bf16_f32 v50, v50, v50
    v_and_b32 v50, 0xffff0000, v50
    v_max_f32 v92, v92, v50
    s_add_u32 s81, s81, 8192
    s_and_b32 s81, s81, 0x3ffff
    buffer_load_dwordx4 v[144:147], v3, s[44:47], s81 offen offset:0 nt
    buffer_load_dwordx4 v[148:151], v3, s[44:47], s81 offen offset:256 nt
    s_waitcnt vmcnt(37)
    v_mfma_f32_16x16x32_bf16 v[64:67], a[160:163], v[8:11], 0
    v_mfma_f32_16x16x32_bf16 v[64:67], a[164:167], v[12:15], v[64:67]
    v_mov_b32_dpp v51, v76 quad_perm:[0,0,0,0] row_mask:0xf bank_mask:0xf
    v_add_f32_dpp v51, v77, v51 quad_perm:[1,1,1,1] row_mask:0xf bank_mask:0xf
    v_add_f32_dpp v51, v78, v51 quad_perm:[2,2,2,2] row_mask:0xf bank_mask:0xf
    v_add_f32_dpp v51, v79, v51 quad_perm:[3,3,3,3] row_mask:0xf bank_mask:0xf
    v_cvt_pk_bf16_f32 v51, v51, v51
    v_and_b32 v51, 0xffff0000, v51
    v_max_f32 v92, v92, v51
    s_add_u32 s81, s81, 8192
    s_and_b32 s81, s81, 0x3ffff
    buffer_load_dwordx4 v[152:155], v3, s[44:47], s81 offen offset:0 nt
    buffer_load_dwordx4 v[156:159], v3, s[44:47], s81 offen offset:256 nt
    s_waitcnt vmcnt(35)
    v_mfma_f32_16x16x32_bf16 v[68:71], a[168:171], v[8:11], 0
    v_mfma_f32_16x16x32_bf16 v[68:71], a[172:175], v[12:15], v[68:71]
    v_mov_b32_dpp v52, v64 quad_perm:[0,0,0,0] row_mask:0xf bank_mask:0xf
    v_add_f32_dpp v52, v65, v52 quad_perm:[1,1,1,1] row_mask:0xf bank_mask:0xf
    v_add_f32_dpp v52, v66, v52 quad_perm:[2,2,2,2] row_mask:0xf bank_mask:0xf
    v_add_f32_dpp v52, v67, v52 quad_perm:[3,3,3,3] row_mask:0xf bank_mask:0xf
    v_cvt_pk_bf16_f32 v52, v52, v52
    v_and_b32 v52, 0xffff0000, v52
    v_max_f32 v92, v92, v52
    s_add_u32 s81, s81, 8192
    s_and_b32 s81, s81, 0x3ffff
    buffer_load_dwordx4 v[160:163], v3, s[44:47], s81 offen offset:0 nt
    buffer_load_dwordx4 v[164:167], v3, s[44:47], s81 offen offset:256 nt
    s_waitcnt vmcnt(33)
    v_mfma_f32_16x16x32_bf16 v[72:75], a[176:179], v[8:11], 0
    v_mfma_f32_16x16x32_bf16 v[72:75], a[180:183], v[12:15], v[72:75]
    v_mov_b32_dpp v53, v68 quad_perm:[0,0,0,0] row_mask:0xf bank_mask:0xf
    v_add_f32_dpp v53, v69, v53 quad_perm:[1,1,1,1] row_mask:0xf bank_mask:0xf
    v_add_f32_dpp v53, v70, v53 quad_perm:[2,2,2,2] row_mask:0xf bank_mask:0xf
    v_add_f32_dpp v53, v71, v53 quad_perm:[3,3,3,3] row_mask:0xf bank_mask:0xf
    v_cvt_pk_bf16_f32 v53, v53, v53
    v_and_b32 v53, 0xffff0000, v53
    v_max_f32 v92, v92, v53
    s_add_u32 s81, s81, 8192
    s_and_b32 s81, s81, 0x3ffff
    buffer_load_dwordx4 v[168:171], v3, s[44:47], s81 offen offset:0 nt
    buffer_load_dwordx4 v[172:175], v3, s[44:47], s81 offen offset:256 nt
    s_waitcnt vmcnt(31)
    v_mfma_f32_16x16x32_bf16 v[76:79], a[184:187], v[8:11], 0
    v_mfma_f32_16x16x32_bf16 v[76:79], a[188:191], v[12:15], v[76:79]
    v_mov_b32_dpp v54, v72 quad_perm:[0,0,0,0] row_mask:0xf bank_mask:0xf
    v_add_f32_dpp v54, v73, v54 quad_perm:[1,1,1,1] row_mask:0xf bank_mask:0xf
    v_add_f32_dpp v54, v74, v54 quad_perm:[2,2,2,2] row_mask:0xf bank_mask:0xf
    v_add_f32_dpp v54, v75, v54 quad_perm:[3,3,3,3] row_mask:0xf bank_mask:0xf
    v_cvt_pk_bf16_f32 v54, v54, v54
    v_and_b32 v54, 0xffff0000, v54
    v_max_f32 v92, v92, v54
    s_add_u32 s81, s81, 8192
    s_and_b32 s81, s81, 0x3ffff
    buffer_load_dwordx4 v[176:179], v3, s[44:47], s81 offen offset:0 nt
    buffer_load_dwordx4 v[180:183], v3, s[44:47], s81 offen offset:256 nt
    s_waitcnt vmcnt(29)
    v_mfma_f32_16x16x32_bf16 v[64:67], a[192:195], v[8:11], 0
    v_mfma_f32_16x16x32_bf16 v[64:67], a[196:199], v[12:15], v[64:67]
    v_mov_b32_dpp v55, v76 quad_perm:[0,0,0,0] row_mask:0xf bank_mask:0xf
    v_add_f32_dpp v55, v77, v55 quad_perm:[1,1,1,1] row_mask:0xf bank_mask:0xf
    v_add_f32_dpp v55, v78, v55 quad_perm:[2,2,2,2] row_mask:0xf bank_mask:0xf
    v_add_f32_dpp v55, v79, v55 quad_perm:[3,3,3,3] row_mask:0xf bank_mask:0xf
    v_cvt_pk_bf16_f32 v55, v55, v55
    v_and_b32 v55, 0xffff0000, v55
    v_max_f32 v92, v92, v55
    s_add_u32 s81, s81, 8192
    s_and_b32 s81, s81, 0x3ffff
    buffer_load_dwordx4 v[184:187], v3, s[44:47], s81 offen offset:0 nt
    buffer_load_dwordx4 v[188:191], v3, s[44:47], s81 offen offset:256 nt
    s_waitcnt vmcnt(28)
    v_mfma_f32_16x16x32_bf16 v[68:71], a[200:203], v[8:11], 0
    v_mfma_f32_16x16x32_bf16 v[68:71], a[204:207], v[12:15], v[68:71]
    v_mov_b32_dpp v56, v64 quad_perm:[0,0,0,0] row_mask:0xf bank_mask:0xf
    v_add_f32_dpp v56, v65, v56 quad_perm:[1,1,1,1] row_mask:0xf bank_mask:0xf
    v_add_f32_dpp v56, v66, v56 quad_perm:[2,2,2,2] row_mask:0xf bank_mask:0xf
    v_add_f32_dpp v56, v67, v56 quad_perm:[3,3,3,3] row_mask:0xf bank_mask:0xf
    v_cvt_pk_bf16_f32 v56, v56, v56
    v_and_b32 v56, 0xffff0000, v56
    v_max_f32 v92, v92, v56
    s_add_u32 s81, s81, 8192
    s_and_b32 s81, s81, 0x3ffff
    buffer_load_dwordx4 v[192:195], v3, s[44:47], s81 offen offset:0 nt
    buffer_load_dwordx4 v[196:199], v3, s[44:47], s81 offen offset:256 nt
    s_waitcnt vmcnt(28)
    v_mfma_f32_16x16x32_bf16 v[72:75], a[208:211], v[8:11], 0
    v_mfma_f32_16x16x32_bf16 v[72:75], a[212:215], v[12:15], v[72:75]
    v_mov_b32_dpp v57, v68 quad_perm:[0,0,0,0] row_mask:0xf bank_mask:0xf
    v_add_f32_dpp v57, v69, v57 quad_perm:[1,1,1,1] row_mask:0xf bank_mask:0xf
    v_add_f32_dpp v57, v70, v57 quad_perm:[2,2,2,2] row_mask:0xf bank_mask:0xf
    v_add_f32_dpp v57, v71, v57 quad_perm:[3,3,3,3] row_mask:0xf bank_mask:0xf
    v_cvt_pk_bf16_f32 v57, v57, v57
    v_and_b32 v57, 0xffff0000, v57
    v_max_f32 v92, v92, v57
    s_add_u32 s81, s81, 8192
    s_and_b32 s81, s81, 0x3ffff
    buffer_load_dwordx4 v[200:203], v3, s[44:47], s81 offen offset:0 nt
    buffer_load_dwordx4 v[204:207], v3, s[44:47], s81 offen offset:256 nt
    s_waitcnt vmcnt(28)
    v_mfma_f32_16x16x32_bf16 v[76:79], a[216:219], v[8:11], 0
    v_mfma_f32_16x16x32_bf16 v[76:79], a[220:223], v[12:15], v[76:79]
    v_mov_b32_dpp v58, v72 quad_perm:[0,0,0,0] row_mask:0xf bank_mask:0xf
    v_add_f32_dpp v58, v73, v58 quad_perm:[1,1,1,1] row_mask:0xf bank_mask:0xf
    v_add_f32_dpp v58, v74, v58 quad_perm:[2,2,2,2] row_mask:0xf bank_mask:0xf
    v_add_f32_dpp v58, v75, v58 quad_perm:[3,3,3,3] row_mask:0xf bank_mask:0xf
    v_cvt_pk_bf16_f32 v58, v58, v58
    v_and_b32 v58, 0xffff0000, v58
    v_max_f32 v92, v92, v58
    s_add_u32 s81, s81, 8192
    s_and_b32 s81, s81, 0x3ffff
    buffer_load_dwordx4 v[208:211], v3, s[44:47], s81 offen offset:0 nt
    buffer_load_dwordx4 v[212:215], v3, s[44:47], s81 offen offset:256 nt
    s_waitcnt vmcnt(28)
    v_mfma_f32_16x16x32_bf16 v[64:67], a[224:227], v[8:11], 0
    v_mfma_f32_16x16x32_bf16 v[64:67], a[228:231], v[12:15], v[64:67]
    v_mov_b32_dpp v59, v76 quad_perm:[0,0,0,0] row_mask:0xf bank_mask:0xf
    v_add_f32_dpp v59, v77, v59 quad_perm:[1,1,1,1] row_mask:0xf bank_mask:0xf
    v_add_f32_dpp v59, v78, v59 quad_perm:[2,2,2,2] row_mask:0xf bank_mask:0xf
    v_add_f32_dpp v59, v79, v59 quad_perm:[3,3,3,3] row_mask:0xf bank_mask:0xf
    v_cvt_pk_bf16_f32 v59, v59, v59
    v_and_b32 v59, 0xffff0000, v59
    v_max_f32 v92, v92, v59
    s_add_u32 s81, s81, 8192
    s_and_b32 s81, s81, 0x3ffff
    buffer_load_dwordx4 v[216:219], v3, s[44:47], s81 offen offset:0 nt
    buffer_load_dwordx4 v[220:223], v3, s[44:47], s81 offen offset:256 nt
    s_waitcnt vmcnt(28)
    v_mfma_f32_16x16x32_bf16 v[68:71], a[232:235], v[8:11], 0
    v_mfma_f32_16x16x32_bf16 v[68:71], a[236:239], v[12:15], v[68:71]
    v_mov_b32_dpp v60, v64 quad_perm:[0,0,0,0] row_mask:0xf bank_mask:0xf
    v_add_f32_dpp v60, v65, v60 quad_perm:[1,1,1,1] row_mask:0xf bank_mask:0xf
    v_add_f32_dpp v60, v66, v60 quad_perm:[2,2,2,2] row_mask:0xf bank_mask:0xf
    v_add_f32_dpp v60, v67, v60 quad_perm:[3,3,3,3] row_mask:0xf bank_mask:0xf
    v_cvt_pk_bf16_f32 v60, v60, v60
    v_and_b32 v60, 0xffff0000, v60
    v_max_f32 v92, v92, v60
    s_add_u32 s81, s81, 8192
    s_and_b32 s81, s81, 0x3ffff
    buffer_load_dwordx4 v[224:227], v3, s[44:47], s81 offen offset:0 nt
    buffer_load_dwordx4 v[228:231], v3, s[44:47], s81 offen offset:256 nt
    s_waitcnt vmcnt(28)
    v_mfma_f32_16x16x32_bf16 v[72:75], a[240:243], v[8:11], 0
    v_mfma_f32_16x16x32_bf16 v[72:75], a[244:247], v[12:15], v[72:75]
    v_mov_b32_dpp v61, v68 quad_perm:[0,0,0,0] row_mask:0xf bank_mask:0xf
    v_add_f32_dpp v61, v69, v61 quad_perm:[1,1,1,1] row_mask:0xf bank_mask:0xf
    v_add_f32_dpp v61, v70, v61 quad_perm:[2,2,2,2] row_mask:0xf bank_mask:0xf
    v_add_f32_dpp v61, v71, v61 quad_perm:[3,3,3,3] row_mask:0xf bank_mask:0xf
    v_cvt_pk_bf16_f32 v61, v61, v61
    v_and_b32 v61, 0xffff0000, v61
    v_max_f32 v92, v92, v61
    s_add_u32 s81, s81, 8192
    s_and_b32 s81, s81, 0x3ffff
    buffer_load_dwordx4 v[232:235], v3, s[44:47], s81 offen offset:0 nt
    buffer_load_dwordx4 v[236:239], v3, s[44:47], s81 offen offset:256 nt
    s_waitcnt vmcnt(28)
    v_mfma_f32_16x16x32_bf16 v[76:79], a[248:251], v[8:11], 0
    v_mfma_f32_16x16x32_bf16 v[76:79], a[252:255], v[12:15], v[76:79]
    v_mov_b32_dpp v62, v72 quad_perm:[0,0,0,0] row_mask:0xf bank_mask:0xf
    v_add_f32_dpp v62, v73, v62 quad_perm:[1,1,1,1] row_mask:0xf bank_mask:0xf
    v_add_f32_dpp v62, v74, v62 quad_perm:[2,2,2,2] row_mask:0xf bank_mask:0xf
    v_add_f32_dpp v62, v75, v62 quad_perm:[3,3,3,3] row_mask:0xf bank_mask:0xf
    v_cvt_pk_bf16_f32 v62, v62, v62
    v_and_b32 v62, 0xffff0000, v62
    v_max_f32 v92, v92, v62
    s_add_u32 s81, s81, 8192
    s_and_b32 s81, s81, 0x3ffff
    buffer_load_dwordx4 v[240:243], v3, s[44:47], s81 offen offset:0 nt
    buffer_load_dwordx4 v[244:247], v3, s[44:47], s81 offen offset:256 nt
    s_add_u32 s81, s81, 8192
    s_and_b32 s81, s81, 0x3ffff
    buffer_load_dwordx4 v[248:251], v3, s[44:47], s81 offen offset:0 nt
    buffer_load_dwordx4 v[252:255], v3, s[44:47], s81 offen offset:256 nt
    s_add_u32 s81, s81, 8192
    s_and_b32 s81, s81, 0x3ffff
    buffer_load_dwordx4 a[0:3], v3, s[44:47], s81 offen offset:0 nt
    buffer_load_dwordx4 a[4:7], v3, s[44:47], s81 offen offset:256 nt
    s_add_u32 s81, s81, 8192
    s_and_b32 s81, s81, 0x3ffff
    buffer_load_dwordx4 a[8:11], v3, s[44:47], s81 offen offset:0 nt
    buffer_load_dwordx4 a[12:15], v3, s[44:47], s81 offen offset:256 nt
    v_mov_b32_dpp v63, v76 quad_perm:[0,0,0,0] row_mask:0xf bank_mask:0xf
    v_add_f32_dpp v63, v77, v63 quad_perm:[1,1,1,1] row_mask:0xf bank_mask:0xf
    v_add_f32_dpp v63, v78, v63 quad_perm:[2,2,2,2] row_mask:0xf bank_mask:0xf
    v_add_f32_dpp v63, v79, v63 quad_perm:[3,3,3,3] row_mask:0xf bank_mask:0xf
    v_cvt_pk_bf16_f32 v63, v63, v63
    v_and_b32 v63, 0xffff0000, v63
    v_max_f32 v92, v92, v63
    v_mov_b32 v93, v92
    s_nop 1
    v_permlane32_swap_b32 v92, v93
    v_max_f32 v92, v92, v93
    v_mov_b32 v93, v92
    s_nop 1
    v_permlane16_swap_b32 v92, v93
    v_max_f32 v92, v92, v93
    v_bfe_u32 v93, v1, 2, 1
    v_lshlrev_b32 v94, 4, v93
    s_lshl_b32 s75, s71, 2
    v_add_u32 v93, s75, v94
    s_mov_b64 exec, 0x11
    ds_write_b32 v93, v92 offset:4224
    s_mov_b64 exec, -1
    s_waitcnt vmcnt(50)
    s_waitcnt lgkmcnt(0)
    s_barrier
    ds_read_b128 v[96:99], v94 offset:4224
    s_cmp_eq_u32 s71, 2
    s_cselect_b32 s12, 320, 0
    s_cmp_eq_u32 s71, 3
    s_cselect_b32 s12, 608, s12
    v_lshrrev_b32 v100, 4, v1
    v_bfe_u32 v76, v1, 2, 2
    v_lshl_add_u32 v76, v100, 3, v76
    v_mul_u32_u24 v76, 896, v76
    v_and_b32 v102, 3, v1
    v_lshl_add_u32 v76, v102, 3, v76
    v_add_u32 v76, s12, v76
    v_lshlrev_b32 v100, 4, v100
    ds_read_b128 v[80:83], v100 offset:4096
    v_add_u32 v77, 70272, v76
    s_waitcnt lgkmcnt(0)
    ds_read_b64_tr_b16 a[208:209], v77 offset:0
    ds_read_b64_tr_b16 a[210:211], v77 offset:3584
    ds_read_b64_tr_b16 a[212:213], v77 offset:32
    ds_read_b64_tr_b16 a[214:215], v77 offset:3616
    ds_read_b64_tr_b16 a[216:217], v77 offset:64
    ds_read_b64_tr_b16 a[218:219], v77 offset:3648
    ds_read_b64_tr_b16 a[220:221], v77 offset:96
    ds_read_b64_tr_b16 a[222:223], v77 offset:3680
    ds_read_b64_tr_b16 a[224:225], v77 offset:128
    ds_read_b64_tr_b16 a[226:227], v77 offset:3712
    ds_read_b64_tr_b16 a[228:229], v77 offset:160
    ds_read_b64_tr_b16 a[230:231], v77 offset:3744
    ds_read_b64_tr_b16 a[232:233], v77 offset:192
    ds_read_b64_tr_b16 a[234:235], v77 offset:3776
    ds_read_b64_tr_b16 a[236:237], v77 offset:224
    ds_read_b64_tr_b16 a[238:239], v77 offset:3808
    ds_read_b64_tr_b16 a[240:241], v77 offset:256
    ds_read_b64_tr_b16 a[242:243], v77 offset:3840
    ds_read_b64_tr_b16 a[244:245], v77 offset:288
    ds_read_b64_tr_b16 a[246:247], v77 offset:3872
    v_max3_f32 v92, v96, v97, v98
    v_max_f32 v92, v92, v99
    v_mul_f32 v92, s82, v92
    v_fma_f32 v32, v32, s82, -v92
    v_fma_f32 v33, v33, s82, -v92
    v_fma_f32 v34, v34, s82, -v92
    v_fma_f32 v35, v35, s82, -v92
    v_exp_f32 v32, v32
    v_exp_f32 v33, v33
    v_exp_f32 v34, v34
    v_exp_f32 v35, v35
    v_mov_b32 v24, v32
    v_mov_b32 v25, v33
    v_add_f32 v24, v24, v34
    v_add_f32 v25, v25, v35
    v_cvt_pk_bf16_f32 v32, v32, v32
    v_cvt_pk_bf16_f32 v33, v33, v33
    v_cvt_pk_bf16_f32 v34, v34, v34
    v_cvt_pk_bf16_f32 v35, v35, v35
    s_add_u32 s81, s81, 8192
    s_and_b32 s81, s81, 0x3ffff
    buffer_load_dwordx4 a[16:19], v3, s[44:47], s81 offen offset:0 nt
    v_fma_f32 v36, v36, s82, -v92
    v_fma_f32 v37, v37, s82, -v92
    v_fma_f32 v38, v38, s82, -v92
    v_fma_f32 v39, v39, s82, -v92
    v_exp_f32 v36, v36
    v_exp_f32 v37, v37
    v_exp_f32 v38, v38
    v_exp_f32 v39, v39
    v_add_f32 v24, v24, v36
    v_add_f32 v25, v25, v37
    v_add_f32 v24, v24, v38
    v_add_f32 v25, v25, v39
    v_cvt_pk_bf16_f32 v36, v36, v36
    v_cvt_pk_bf16_f32 v37, v37, v37
    v_cvt_pk_bf16_f32 v38, v38, v38
    v_cvt_pk_bf16_f32 v39, v39, v39
    buffer_load_dwordx4 a[20:23], v3, s[44:47], s81 offen offset:256 nt
    v_fma_f32 v40, v40, s82, -v92
    v_fma_f32 v41, v41, s82, -v92
    v_fma_f32 v42, v42, s82, -v92
    v_fma_f32 v43, v43, s82, -v92
    v_exp_f32 v40, v40
    v_exp_f32 v41, v41
    v_exp_f32 v42, v42
    v_exp_f32 v43, v43
    v_add_f32 v24, v24, v40
    v_add_f32 v25, v25, v41
    v_add_f32 v24, v24, v42
    v_add_f32 v25, v25, v43
    v_cvt_pk_bf16_f32 v40, v40, v40
    v_cvt_pk_bf16_f32 v41, v41, v41
    v_cvt_pk_bf16_f32 v42, v42, v42
    v_cvt_pk_bf16_f32 v43, v43, v43
    s_add_u32 s81, s81, 8192
    s_and_b32 s81, s81, 0x3ffff
    buffer_load_dwordx4 a[24:27], v3, s[44:47], s81 offen offset:0 nt
    v_fma_f32 v44, v44, s82, -v92
    v_fma_f32 v45, v45, s82, -v92
    v_fma_f32 v46, v46, s82, -v92
    v_fma_f32 v47, v47, s82, -v92
    v_exp_f32 v44, v44
    v_exp_f32 v45, v45
    v_exp_f32 v46, v46
    v_exp_f32 v47, v47
    v_add_f32 v24, v24, v44
    v_add_f32 v25, v25, v45
    v_add_f32 v24, v24, v46
    v_add_f32 v25, v25, v47
    v_cvt_pk_bf16_f32 v44, v44, v44
    v_cvt_pk_bf16_f32 v45, v45, v45
    v_cvt_pk_bf16_f32 v46, v46, v46
    v_cvt_pk_bf16_f32 v47, v47, v47
    buffer_load_dwordx4 a[28:31], v3, s[44:47], s81 offen offset:256 nt
    v_fma_f32 v48, v48, s82, -v92
    v_fma_f32 v49, v49, s82, -v92
    v_fma_f32 v50, v50, s82, -v92
    v_fma_f32 v51, v51, s82, -v92
    v_exp_f32 v48, v48
    v_exp_f32 v49, v49
    v_exp_f32 v50, v50
    v_exp_f32 v51, v51
    v_add_f32 v24, v24, v48
    v_add_f32 v25, v25, v49
    v_add_f32 v24, v24, v50
    v_add_f32 v25, v25, v51
    v_cvt_pk_bf16_f32 v48, v48, v48
    v_cvt_pk_bf16_f32 v49, v49, v49
    v_cvt_pk_bf16_f32 v50, v50, v50
    v_cvt_pk_bf16_f32 v51, v51, v51
    s_add_u32 s81, s81, 8192
    s_and_b32 s81, s81, 0x3ffff
    buffer_load_dwordx4 a[32:35], v3, s[44:47], s81 offen offset:0 nt
    v_fma_f32 v52, v52, s82, -v92
    v_fma_f32 v53, v53, s82, -v92
    v_fma_f32 v54, v54, s82, -v92
    v_fma_f32 v55, v55, s82, -v92
    v_exp_f32 v52, v52
    v_exp_f32 v53, v53
    v_exp_f32 v54, v54
    v_exp_f32 v55, v55
    v_add_f32 v24, v24, v52
    v_add_f32 v25, v25, v53
    v_add_f32 v24, v24, v54
    v_add_f32 v25, v25, v55
    v_cvt_pk_bf16_f32 v52, v52, v52
    v_cvt_pk_bf16_f32 v53, v53, v53
    v_cvt_pk_bf16_f32 v54, v54, v54
    v_cvt_pk_bf16_f32 v55, v55, v55
    buffer_load_dwordx4 a[36:39], v3, s[44:47], s81 offen offset:256 nt
    v_fma_f32 v56, v56, s82, -v92
    v_fma_f32 v57, v57, s82, -v92
    v_fma_f32 v58, v58, s82, -v92
    v_fma_f32 v59, v59, s82, -v92
    v_exp_f32 v56, v56
    v_exp_f32 v57, v57
    v_exp_f32 v58, v58
    v_exp_f32 v59, v59
    v_add_f32 v24, v24, v56
    v_add_f32 v25, v25, v57
    v_add_f32 v24, v24, v58
    v_add_f32 v25, v25, v59
    v_cvt_pk_bf16_f32 v56, v56, v56
    v_cvt_pk_bf16_f32 v57, v57, v57
    v_cvt_pk_bf16_f32 v58, v58, v58
    v_cvt_pk_bf16_f32 v59, v59, v59
    s_add_u32 s81, s81, 8192
    s_and_b32 s81, s81, 0x3ffff
    buffer_load_dwordx4 a[40:43], v3, s[44:47], s81 offen offset:0 nt
    v_fma_f32 v60, v60, s82, -v92
    v_fma_f32 v61, v61, s82, -v92
    v_fma_f32 v62, v62, s82, -v92
    v_fma_f32 v63, v63, s82, -v92
    v_exp_f32 v60, v60
    v_exp_f32 v61, v61
    v_exp_f32 v62, v62
    v_exp_f32 v63, v63
    v_add_f32 v24, v24, v60
    v_add_f32 v25, v25, v61
    v_add_f32 v24, v24, v62
    v_add_f32 v25, v25, v63
    v_cvt_pk_bf16_f32 v60, v60, v60
    v_cvt_pk_bf16_f32 v61, v61, v61
    v_cvt_pk_bf16_f32 v62, v62, v62
    v_cvt_pk_bf16_f32 v63, v63, v63
    buffer_load_dwordx4 a[44:47], v3, s[44:47], s81 offen offset:256 nt
    v_add_f32 v24, v24, v25
    v_bfe_u32 v94, v1, 2, 1
    v_mov_b32 v25, v24
    v_lshlrev_b32 v94, 4, v94
    s_nop 0
    v_permlane32_swap_b32 v24, v25
    s_lshl_b32 s75, s71, 2
    v_add_f32 v24, v24, v25
    v_add_u32 v94, s75, v94
    v_mov_b32 v25, v24
    s_nop 1
    v_permlane16_swap_b32 v24, v25
    v_add_f32 v24, v24, v25
    s_mov_b64 exec, 0x11
    ds_write_b32 v94, v24 offset:4352
    s_mov_b64 exec, -1
    s_waitcnt lgkmcnt(0)
    s_barrier
    ds_read_b64_tr_b16 a[128:129], v76 offset:12928
    ds_read_b64_tr_b16 a[130:131], v76 offset:16512
    ds_read_b64_tr_b16 a[132:133], v76 offset:12960
    ds_read_b64_tr_b16 a[134:135], v76 offset:16544
    ds_read_b64_tr_b16 a[136:137], v76 offset:12992
    ds_read_b64_tr_b16 a[138:139], v76 offset:16576
    ds_read_b64_tr_b16 a[140:141], v76 offset:13024
    ds_read_b64_tr_b16 a[142:143], v76 offset:16608
    ds_read_b64_tr_b16 a[144:145], v76 offset:13056
    ds_read_b64_tr_b16 a[146:147], v76 offset:16640
    ds_read_b64_tr_b16 a[148:149], v76 offset:13088
    ds_read_b64_tr_b16 a[150:151], v76 offset:16672
    ds_read_b64_tr_b16 a[152:153], v76 offset:13120
    ds_read_b64_tr_b16 a[154:155], v76 offset:16704
    ds_read_b64_tr_b16 a[156:157], v76 offset:13152
    ds_read_b64_tr_b16 a[158:159], v76 offset:16736
    ds_read_b64_tr_b16 a[160:161], v76 offset:13184
    ds_read_b64_tr_b16 a[162:163], v76 offset:16768
    ds_read_b64_tr_b16 a[164:165], v76 offset:13216
    ds_read_b64_tr_b16 a[166:167], v76 offset:16800
    ds_read_b64_tr_b16 a[168:169], v76 offset:41600
    ds_read_b64_tr_b16 a[170:171], v76 offset:45184
    ds_read_b64_tr_b16 a[172:173], v76 offset:41632
    ds_read_b64_tr_b16 a[174:175], v76 offset:45216
    ds_read_b64_tr_b16 a[176:177], v76 offset:41664
    ds_read_b64_tr_b16 a[178:179], v76 offset:45248
    ds_read_b64_tr_b16 a[180:181], v76 offset:41696
    ds_read_b64_tr_b16 a[182:183], v76 offset:45280
    ds_read_b64_tr_b16 a[184:185], v76 offset:41728
    ds_read_b64_tr_b16 a[186:187], v76 offset:45312
    ds_read_b64_tr_b16 a[188:189], v76 offset:41760
    ds_read_b64_tr_b16 a[190:191], v76 offset:45344
    ds_read_b64_tr_b16 a[192:193], v76 offset:41792
    ds_read_b64_tr_b16 a[194:195], v76 offset:45376
    ds_read_b64_tr_b16 a[196:197], v76 offset:41824
    ds_read_b64_tr_b16 a[198:199], v76 offset:45408
    ds_read_b64_tr_b16 a[200:201], v76 offset:41856
    ds_read_b64_tr_b16 a[202:203], v76 offset:45440
    ds_read_b64_tr_b16 a[204:205], v76 offset:41888
    ds_read_b64_tr_b16 a[206:207], v76 offset:45472
    s_mov_b32 s86, 0xffff0000
    s_mov_b32 s87, 0xffff0000
    s_mov_b32 s88, 0
    s_mov_b32 s89, -1
    v_mfma_f32_16x16x32_bf16 v[96:99], v[80:83], a[208:211], 0
    v_mfma_f32_16x16x32_bf16 v[100:103], v[80:83], a[212:215], 0
    v_mfma_f32_16x16x32_bf16 v[104:107], v[80:83], a[216:219], 0
    v_mfma_f32_16x16x32_bf16 v[108:111], v[80:83], a[220:223], 0
    v_mfma_f32_16x16x32_bf16 v[112:115], v[80:83], a[224:227], 0
    v_mfma_f32_16x16x32_bf16 v[116:119], v[80:83], a[228:231], 0
    v_mfma_f32_16x16x32_bf16 v[120:123], v[80:83], a[232:235], 0
    v_mfma_f32_16x16x32_bf16 v[124:127], v[80:83], a[236:239], 0
    v_mov_b32 v65, s72
    v_mov_b32 v67, s72
    v_mov_b32 v69, s72
    v_mov_b32 v71, s72
    v_mov_b32 v73, s72
    v_mov_b32 v75, s72
    v_cndmask_b32 v93, v96, v100, s[86:87]
    v_cndmask_b32 v94, v104, v108, s[86:87]
    v_cndmask_b32 v78, v93, v94, s[88:89]
    v_cndmask_b32 v93, v112, v116, s[86:87]
    v_cndmask_b32 v94, v120, v124, s[86:87]
    v_cndmask_b32 v79, v93, v94, s[88:89]
    v_mfma_f32_16x16x32_bf16 v[96:99], v[80:83], a[240:243], 0
    v_mfma_f32_16x16x32_bf16 v[100:103], v[80:83], a[244:247], 0
    v_mul_f32 v78, s95, v78
    v_mul_f32 v79, s95, v79
    s_nop 5
    v_cndmask_b32 v15, v96, v100, s[86:87]
    v_mul_f32 v15, s95, v15
    s_cmp_lg_u32 s71, 2
    s_cbranch_scc1 L_ml_done
    v_bfe_u32 v94, v1, 2, 1
    v_lshlrev_b32 v94, 4, v94
    s_mov_b64 exec, 0x11
    ds_read_b128 v[108:111], v94 offset:4352
    s_lshl_b32 s75, s74, 10
    s_lshl_b32 s76, s69, 7
    s_add_u32 s75, s75, s76
    s_add_u32 s75, s75, 131072
    v_mov_b32 v120, v92
    v_mov_b32 v121, s72
    v_mov_b32 v123, s72
    s_waitcnt lgkmcnt(0)
    v_add_f32 v108, v108, v109
    v_add_f32 v110, v110, v111
    v_add_f32 v122, v108, v110
    buffer_store_dwordx4 v[120:123], v94, s[60:63], s75 offen
    s_mov_b64 exec, -1
L_ml_done:
    v_lshrrev_b32 v93, 4, v1
    v_and_b32 v94, 1, v93
    s_lshl_b32 s75, s71, 11
    v_lshlrev_b32 v8, 10, v94
    v_add_u32 v8, s75, v8
    v_lshrrev_b32 v93, 1, v93
    v_lshl_add_u32 v8, v93, 4, v8
    v_and_b32 v93, 15, v1
    v_lshl_add_u32 v8, v93, 5, v8
    s_cmp_eq_u32 s71, 1
    s_cselect_b32 s75, 0, s71
    s_lshl_b32 s76, s75, 9
    v_lshlrev_b32 v10, 3, v1
    v_add_u32 v10, s76, v10
    s_lshl_b32 s76, s75, 13
    v_lshrrev_b32 v93, 5, v1
    v_lshlrev_b32 v11, 12, v93
    v_add_u32 v11, s76, v11
    v_and_b32 v93, 31, v1
    v_lshl_add_u32 v11, v93, 4, v11
    s_lshr_b32 s75, s12, 4
    v_lshrrev_b32 v12, 3, v1
    v_add_u32 v12, s75, v12
    v_lshlrev_b32 v12, 12, v12
    v_bfe_u32 v13, v1, 1, 2
    v_lshl_add_u32 v12, v13, 4, v12
    v_add_u32 v13, 32768, v12
    v_add_u32 v14, 65536, v12
    v_lshrrev_b32 v88, 4, v1
    v_lshlrev_b32 v88, 4, v88
    v_and_b32 v89, 31, v1
    v_lshlrev_b32 v89, 2, v89
    v_lshrrev_b32 v90, 5, v1
    v_lshlrev_b32 v90, 7, v90
    v_bfe_u32 v2, v1, 2, 1
    v_lshlrev_b32 v2, 4, v2
    s_lshl_b32 s4, s74, 15
    s_lshl_b32 s76, s69, 9
    s_add_u32 s5, s4, 262144
    s_add_u32 s4, s5, s76
    s_add_u32 s13, s4, 8192
    s_lshl_b32 s76, s69, 12
    s_add_u32 s5, s5, s76
    s_lshl_b32 s6, s74, 10
    s_add_u32 s6, s6, 131072
    s_lshr_b32 s76, s69, 2
    s_lshl_b32 s76, s76, 4
    s_add_u32 s7, s6, s76
    s_lshl_b32 s76, s69, 7
    s_add_u32 s6, s6, s76
    s_mul_i32 s8, s70, 229376
    s_add_u32 s8, s8, 2097152
    s_lshl_b32 s76, s73, 12
    s_add_u32 s9, s8, s76
    s_lshl_b32 s76, s73, 6
    s_add_u32 s8, s8, s76
    s_mul_i32 s11, s70, 896
    s_lshl_b32 s76, s73, 4
    s_add_u32 s11, s11, s76
    s_mov_b32 s91, 0
    v_and_b32 v80, v32, v4
    v_and_b32 v81, v32, v5
    v_and_b32 v82, v32, v6
    v_and_b32 v83, v32, v7
    v_and_b32 v84, v33, v4
    v_and_b32 v85, v33, v5
    v_and_b32 v86, v33, v6
    v_and_b32 v87, v33, v7
    s_waitcnt vmcnt(42)
    v_mfma_f32_16x16x32_bf16 v[16:19], v[80:83], v[128:131], 0
    v_mfma_f32_16x16x32_bf16 v[20:23], v[80:83], v[132:135], 0
    v_and_b32 v80, v34, v4
    v_and_b32 v81, v34, v5
    v_and_b32 v82, v34, v6
    v_and_b32 v83, v34, v7
    s_waitcnt vmcnt(40)
    v_mfma_f32_16x16x32_bf16 v[16:19], v[84:87], v[136:139], v[16:19]
    v_mfma_f32_16x16x32_bf16 v[20:23], v[84:87], v[140:143], v[20:23]
    v_and_b32 v84, v35, v4
    v_and_b32 v85, v35, v5
    v_and_b32 v86, v35, v6
    v_and_b32 v87, v35, v7
    s_waitcnt vmcnt(38)
    v_mfma_f32_16x16x32_bf16 v[16:19], v[80:83], v[144:147], v[16:19]
    v_mfma_f32_16x16x32_bf16 v[20:23], v[80:83], v[148:151], v[20:23]
    v_and_b32 v80, v36, v4
    v_and_b32 v81, v36, v5
    v_and_b32 v82, v36, v6
    v_and_b32 v83, v36, v7
    s_waitcnt vmcnt(36)
    v_mfma_f32_16x16x32_bf16 v[16:19], v[84:87], v[152:155], v[16:19]
    v_mfma_f32_16x16x32_bf16 v[20:23], v[84:87], v[156:159], v[20:23]
    v_and_b32 v84, v37, v4
    v_and_b32 v85, v37, v5
    v_and_b32 v86, v37, v6
    v_and_b32 v87, v37, v7
    s_waitcnt vmcnt(34)
    v_mfma_f32_16x16x32_bf16 v[16:19], v[80:83], v[160:163], v[16:19]
    v_mfma_f32_16x16x32_bf16 v[20:23], v[80:83], v[164:167], v[20:23]
    v_and_b32 v80, v38, v4
    v_and_b32 v81, v38, v5
    v_and_b32 v82, v38, v6
    v_and_b32 v83, v38, v7
    s_waitcnt vmcnt(32)
    v_mfma_f32_16x16x32_bf16 v[16:19], v[84:87], v[168:171], v[16:19]
    v_mfma_f32_16x16x32_bf16 v[20:23], v[84:87], v[172:175], v[20:23]
    v_and_b32 v84, v39, v4
    v_and_b32 v85, v39, v5
    v_and_b32 v86, v39, v6
    v_and_b32 v87, v39, v7
    s_waitcnt vmcnt(30)
    v_mfma_f32_16x16x32_bf16 v[16:19], v[80:83], v[176:179], v[16:19]
    v_mfma_f32_16x16x32_bf16 v[20:23], v[80:83], v[180:183], v[20:23]
    v_and_b32 v80, v40, v4
    v_and_b32 v81, v40, v5
    v_and_b32 v82, v40, v6
    v_and_b32 v83, v40, v7
    s_waitcnt vmcnt(28)
    v_mfma_f32_16x16x32_bf16 v[16:19], v[84:87], v[184:187], v[16:19]
    v_mfma_f32_16x16x32_bf16 v[20:23], v[84:87], v[188:191], v[20:23]
    s_add_u32 s81, s81, 8192
    s_and_b32 s81, s81, 0x3ffff
    buffer_load_dwordx4 a[48:51], v3, s[44:47], s81 offen offset:0 nt
    buffer_load_dwordx4 a[52:55], v3, s[44:47], s81 offen offset:256 nt
    v_and_b32 v84, v41, v4
    v_and_b32 v85, v41, v5
    v_and_b32 v86, v41, v6
    v_and_b32 v87, v41, v7
    s_waitcnt vmcnt(28)
    v_mfma_f32_16x16x32_bf16 v[16:19], v[80:83], v[192:195], v[16:19]
    v_mfma_f32_16x16x32_bf16 v[20:23], v[80:83], v[196:199], v[20:23]
    s_add_u32 s81, s81, 8192
    s_and_b32 s81, s81, 0x3ffff
    buffer_load_dwordx4 a[56:59], v3, s[44:47], s81 offen offset:0 nt
    buffer_load_dwordx4 a[60:63], v3, s[44:47], s81 offen offset:256 nt
    v_and_b32 v80, v42, v4
    v_and_b32 v81, v42, v5
    v_and_b32 v82, v42, v6
    v_and_b32 v83, v42, v7
    s_waitcnt vmcnt(28)
    v_mfma_f32_16x16x32_bf16 v[16:19], v[84:87], v[200:203], v[16:19]
    v_mfma_f32_16x16x32_bf16 v[20:23], v[84:87], v[204:207], v[20:23]
    s_add_u32 s81, s81, 8192
    s_and_b32 s81, s81, 0x3ffff
    buffer_load_dwordx4 a[64:67], v3, s[44:47], s81 offen offset:0 nt
    buffer_load_dwordx4 a[68:71], v3, s[44:47], s81 offen offset:256 nt
    v_and_b32 v84, v43, v4
    v_and_b32 v85, v43, v5
    v_and_b32 v86, v43, v6
    v_and_b32 v87, v43, v7
    s_waitcnt vmcnt(28)
    v_mfma_f32_16x16x32_bf16 v[16:19], v[80:83], v[208:211], v[16:19]
    v_mfma_f32_16x16x32_bf16 v[20:23], v[80:83], v[212:215], v[20:23]
    s_add_u32 s81, s81, 8192
    s_and_b32 s81, s81, 0x3ffff
    buffer_load_dwordx4 a[72:75], v3, s[44:47], s81 offen offset:0 nt
    buffer_load_dwordx4 a[76:79], v3, s[44:47], s81 offen offset:256 nt
    v_and_b32 v80, v44, v4
    v_and_b32 v81, v44, v5
    v_and_b32 v82, v44, v6
    v_and_b32 v83, v44, v7
    s_waitcnt vmcnt(28)
    v_mfma_f32_16x16x32_bf16 v[16:19], v[84:87], v[216:219], v[16:19]
    v_mfma_f32_16x16x32_bf16 v[20:23], v[84:87], v[220:223], v[20:23]
    s_add_u32 s81, s81, 8192
    s_and_b32 s81, s81, 0x3ffff
    buffer_load_dwordx4 a[80:83], v3, s[44:47], s81 offen offset:0 nt
    buffer_load_dwordx4 a[84:87], v3, s[44:47], s81 offen offset:256 nt
    v_and_b32 v84, v45, v4
    v_and_b32 v85, v45, v5
    v_and_b32 v86, v45, v6
    v_and_b32 v87, v45, v7
    s_waitcnt vmcnt(28)
    v_mfma_f32_16x16x32_bf16 v[16:19], v[80:83], v[224:227], v[16:19]
    v_mfma_f32_16x16x32_bf16 v[20:23], v[80:83], v[228:231], v[20:23]
    s_add_u32 s81, s81, 8192
    s_and_b32 s81, s81, 0x3ffff
    buffer_load_dwordx4 a[88:91], v3, s[44:47], s81 offen offset:0 nt
    buffer_load_dwordx4 a[92:95], v3, s[44:47], s81 offen offset:256 nt
    v_and_b32 v80, v46, v4
    v_and_b32 v81, v46, v5
    v_and_b32 v82, v46, v6
    v_and_b32 v83, v46, v7
    s_waitcnt vmcnt(28)
    v_mfma_f32_16x16x32_bf16 v[16:19], v[84:87], v[232:235], v[16:19]
    v_mfma_f32_16x16x32_bf16 v[20:23], v[84:87], v[236:239], v[20:23]
    s_add_u32 s81, s81, 8192
    s_and_b32 s81, s81, 0x3ffff
    buffer_load_dwordx4 a[96:99], v3, s[44:47], s81 offen offset:0 nt
    buffer_load_dwordx4 a[100:103], v3, s[44:47], s81 offen offset:256 nt
    v_and_b32 v84, v47, v4
    v_and_b32 v85, v47, v5
    v_and_b32 v86, v47, v6
    v_and_b32 v87, v47, v7
    s_waitcnt vmcnt(28)
    v_mfma_f32_16x16x32_bf16 v[16:19], v[80:83], v[240:243], v[16:19]
    v_mfma_f32_16x16x32_bf16 v[20:23], v[80:83], v[244:247], v[20:23]
    s_add_u32 s81, s81, 8192
    s_and_b32 s81, s81, 0x3ffff
    buffer_load_dwordx4 a[104:107], v3, s[44:47], s81 offen offset:0 nt
    buffer_load_dwordx4 a[108:111], v3, s[44:47], s81 offen offset:256 nt
    v_and_b32 v80, v48, v4
    v_and_b32 v81, v48, v5
    v_and_b32 v82, v48, v6
    v_and_b32 v83, v48, v7
    s_waitcnt vmcnt(28)
    v_mfma_f32_16x16x32_bf16 v[16:19], v[84:87], v[248:251], v[16:19]
    v_mfma_f32_16x16x32_bf16 v[20:23], v[84:87], v[252:255], v[20:23]
    s_add_u32 s81, s81, 8192
    s_and_b32 s81, s81, 0x3ffff
    buffer_load_dwordx4 a[112:115], v3, s[44:47], s81 offen offset:0 nt
    buffer_load_dwordx4 a[116:119], v3, s[44:47], s81 offen offset:256 nt
    v_and_b32 v84, v49, v4
    v_and_b32 v85, v49, v5
    v_and_b32 v86, v49, v6
    v_and_b32 v87, v49, v7
    s_waitcnt vmcnt(28)
    v_mfma_f32_16x16x32_bf16 v[16:19], v[80:83], a[0:3], v[16:19]
    v_mfma_f32_16x16x32_bf16 v[20:23], v[80:83], a[4:7], v[20:23]
    s_add_u32 s81, s81, 8192
    s_and_b32 s81, s81, 0x3ffff
    buffer_load_dwordx4 a[120:123], v3, s[44:47], s81 offen offset:0 nt
    buffer_load_dwordx4 a[124:127], v3, s[44:47], s81 offen offset:256 nt
    v_and_b32 v80, v50, v4
    v_and_b32 v81, v50, v5
    v_and_b32 v82, v50, v6
    v_and_b32 v83, v50, v7
    s_waitcnt vmcnt(28)
    v_mfma_f32_16x16x32_bf16 v[16:19], v[84:87], a[8:11], v[16:19]
    v_mfma_f32_16x16x32_bf16 v[20:23], v[84:87], a[12:15], v[20:23]
    v_and_b32 v84, v51, v4
    v_and_b32 v85, v51, v5
    v_and_b32 v86, v51, v6
    v_and_b32 v87, v51, v7
    s_waitcnt vmcnt(26)
    v_mfma_f32_16x16x32_bf16 v[16:19], v[80:83], a[16:19], v[16:19]
    v_mfma_f32_16x16x32_bf16 v[20:23], v[80:83], a[20:23], v[20:23]
    v_and_b32 v80, v52, v4
    v_and_b32 v81, v52, v5
    v_and_b32 v82, v52, v6
    v_and_b32 v83, v52, v7
    s_waitcnt vmcnt(24)
    v_mfma_f32_16x16x32_bf16 v[16:19], v[84:87], a[24:27], v[16:19]
    v_mfma_f32_16x16x32_bf16 v[20:23], v[84:87], a[28:31], v[20:23]
    v_and_b32 v84, v53, v4
    v_and_b32 v85, v53, v5
    v_and_b32 v86, v53, v6
    v_and_b32 v87, v53, v7
    s_waitcnt vmcnt(22)
    v_mfma_f32_16x16x32_bf16 v[16:19], v[80:83], a[32:35], v[16:19]
    v_mfma_f32_16x16x32_bf16 v[20:23], v[80:83], a[36:39], v[20:23]
    v_and_b32 v80, v54, v4
    v_and_b32 v81, v54, v5
    v_and_b32 v82, v54, v6
    v_and_b32 v83, v54, v7
    s_waitcnt vmcnt(20)
    v_mfma_f32_16x16x32_bf16 v[16:19], v[84:87], a[40:43], v[16:19]
    v_mfma_f32_16x16x32_bf16 v[20:23], v[84:87], a[44:47], v[20:23]
    v_and_b32 v84, v55, v4
    v_and_b32 v85, v55, v5
    v_and_b32 v86, v55, v6
    v_and_b32 v87, v55, v7
    s_waitcnt vmcnt(18)
    v_mfma_f32_16x16x32_bf16 v[16:19], v[80:83], a[48:51], v[16:19]
    v_mfma_f32_16x16x32_bf16 v[20:23], v[80:83], a[52:55], v[20:23]
    v_and_b32 v80, v56, v4
    v_and_b32 v81, v56, v5
    v_and_b32 v82, v56, v6
    v_and_b32 v83, v56, v7
    s_waitcnt vmcnt(16)
    v_mfma_f32_16x16x32_bf16 v[16:19], v[84:87], a[56:59], v[16:19]
    v_mfma_f32_16x16x32_bf16 v[20:23], v[84:87], a[60:63], v[20:23]
    v_and_b32 v84, v57, v4
    v_and_b32 v85, v57, v5
    v_and_b32 v86, v57, v6
    v_and_b32 v87, v57, v7
    s_waitcnt vmcnt(14)
    v_mfma_f32_16x16x32_bf16 v[16:19], v[80:83], a[64:67], v[16:19]
    v_mfma_f32_16x16x32_bf16 v[20:23], v[80:83], a[68:71], v[20:23]
    v_and_b32 v80, v58, v4
    v_and_b32 v81, v58, v5
    v_and_b32 v82, v58, v6
    v_and_b32 v83, v58, v7
    s_waitcnt vmcnt(12)
    v_mfma_f32_16x16x32_bf16 v[16:19], v[84:87], a[72:75], v[16:19]
    v_mfma_f32_16x16x32_bf16 v[20:23], v[84:87], a[76:79], v[20:23]
    v_and_b32 v84, v59, v4
    v_and_b32 v85, v59, v5
    v_and_b32 v86, v59, v6
    v_and_b32 v87, v59, v7
    s_waitcnt vmcnt(10)
    v_mfma_f32_16x16x32_bf16 v[16:19], v[80:83], a[80:83], v[16:19]
    v_mfma_f32_16x16x32_bf16 v[20:23], v[80:83], a[84:87], v[20:23]
    v_and_b32 v80, v60, v4
    v_and_b32 v81, v60, v5
    v_and_b32 v82, v60, v6
    v_and_b32 v83, v60, v7
    s_waitcnt vmcnt(8)
    v_mfma_f32_16x16x32_bf16 v[16:19], v[84:87], a[88:91], v[16:19]
    v_mfma_f32_16x16x32_bf16 v[20:23], v[84:87], a[92:95], v[20:23]
    v_and_b32 v84, v61, v4
    v_and_b32 v85, v61, v5
    v_and_b32 v86, v61, v6
    v_and_b32 v87, v61, v7
    s_waitcnt vmcnt(6)
    v_mfma_f32_16x16x32_bf16 v[16:19], v[80:83], a[96:99], v[16:19]
    v_mfma_f32_16x16x32_bf16 v[20:23], v[80:83], a[100:103], v[20:23]
    v_and_b32 v80, v62, v4
    v_and_b32 v81, v62, v5
    v_and_b32 v82, v62, v6
    v_and_b32 v83, v62, v7
    s_waitcnt vmcnt(4)
    v_mfma_f32_16x16x32_bf16 v[16:19], v[84:87], a[104:107], v[16:19]
    v_mfma_f32_16x16x32_bf16 v[20:23], v[84:87], a[108:111], v[20:23]
    buffer_load_dwordx4 v[144:147], v90, s[60:63], s7 offen offset:0 sc1
    buffer_load_dwordx4 v[148:151], v90, s[60:63], s7 offen offset:256 sc1
    buffer_load_dwordx4 v[152:155], v90, s[60:63], s7 offen offset:512 sc1
    buffer_load_dwordx4 v[156:159], v90, s[60:63], s7 offen offset:768 sc1
    v_and_b32 v84, v63, v4
    v_and_b32 v85, v63, v5
    v_and_b32 v86, v63, v6
    v_and_b32 v87, v63, v7
    s_waitcnt vmcnt(6)
    v_mfma_f32_16x16x32_bf16 v[16:19], v[80:83], a[112:115], v[16:19]
    v_mfma_f32_16x16x32_bf16 v[20:23], v[80:83], a[116:119], v[20:23]
    s_waitcnt vmcnt(4)
    v_mfma_f32_16x16x32_bf16 v[16:19], v[84:87], a[120:123], v[16:19]
    v_mfma_f32_16x16x32_bf16 v[20:23], v[84:87], a[124:127], v[20:23]
    s_nop 6
    ds_write_b128 v8, v[16:19] offset:4736
    ds_write_b128 v8, v[20:23] offset:5248
    s_waitcnt lgkmcnt(0)
    s_barrier
    s_cmp_eq_u32 s71, 0
    s_cbranch_scc1 L_hop1_poll
    ds_read_b64 v[96:97], v10 offset:4736
    ds_read_b64 v[98:99], v10 offset:6784
    ds_read_b64 v[100:101], v10 offset:8832
    ds_read_b64 v[102:103], v10 offset:10880
    v_mov_b32 v105, s72
    v_mov_b32 v107, s72
    s_cmp_lg_u32 s71, 1
    s_cbranch_scc1 L_o_single
    ds_read_b64 v[108:109], v10 offset:5248
    ds_read_b64 v[110:111], v10 offset:7296
    ds_read_b64 v[112:113], v10 offset:9344
    ds_read_b64 v[114:115], v10 offset:11392
    v_mov_b32 v117, s72
    v_mov_b32 v119, s72
    s_waitcnt lgkmcnt(4)
    v_add_f32 v96, v96, v98
    v_add_f32 v97, v97, v99
    v_add_f32 v100, v100, v102
    v_add_f32 v101, v101, v103
    v_add_f32 v104, v96, v100
    v_add_f32 v106, v97, v101
    buffer_store_dwordx4 v[104:107], v11, s[60:63], s4 offen
    s_waitcnt lgkmcnt(0)
    v_add_f32 v108, v108, v110
    v_add_f32 v109, v109, v111
    v_add_f32 v112, v112, v114
    v_add_f32 v113, v113, v115
    v_add_f32 v116, v108, v112
    v_add_f32 v118, v109, v113
    buffer_store_dwordx4 v[116:119], v11, s[60:63], s13 offen
    s_branch L_o_done
L_o_single:
    s_waitcnt lgkmcnt(0)
    v_add_f32 v96, v96, v98
    v_add_f32 v97, v97, v99
    v_add_f32 v100, v100, v102
    v_add_f32 v101, v101, v103
    v_add_f32 v104, v96, v100
    v_add_f32 v106, v97, v101
    buffer_store_dwordx4 v[104:107], v11, s[60:63], s4 offen
L_o_done:
    s_barrier
    s_branch L_hop1_join
L_hop1_poll:
    s_mov_b32 s90, 0
    s_mov_b32 s85, 24
L_m1_loop:
    s_waitcnt vmcnt(0)
    v_bitop3_b32 v56, v145, v147, s72 bitop3:0x7e
    v_bitop3_b32 v57, v149, v151, s72 bitop3:0x7e
    v_bitop3_b32 v58, v153, v155, s72 bitop3:0x7e
    v_bitop3_b32 v59, v157, v159, s72 bitop3:0x7e
    v_or3_b32 v93, v56, v57, v58
    v_or_b32 v93, v93, v59
    v_cmp_ne_u32 vcc, 0, v93
    s_nop 0
    s_cmp_eq_u64 vcc, 0
    s_cbranch_scc1 L_m1_done
    v_cmp_ne_u32 s[28:29], 0, v56
    v_cmp_ne_u32 s[30:31], 0, v57
    v_cmp_ne_u32 s[32:33], 0, v58
    v_cmp_ne_u32 s[34:35], 0, v59
    s_sub_u32 s85, s85, 1
    s_cbranch_scc1 L_ml_late
    s_mov_b64 exec, s[28:29]
    s_cbranch_execz L_m1_skip0
    buffer_load_dwordx4 v[144:147], v90, s[60:63], s7 offen offset:0 sc1
L_m1_skip0:
    s_mov_b64 exec, s[30:31]
    s_cbranch_execz L_m1_skip1
    buffer_load_dwordx4 v[148:151], v90, s[60:63], s7 offen offset:256 sc1
L_m1_skip1:
    s_mov_b64 exec, s[32:33]
    s_cbranch_execz L_m1_skip2
    buffer_load_dwordx4 v[152:155], v90, s[60:63], s7 offen offset:512 sc1
L_m1_skip2:
    s_mov_b64 exec, s[34:35]
    s_cbranch_execz L_m1_skip3
    buffer_load_dwordx4 v[156:159], v90, s[60:63], s7 offen offset:768 sc1
L_m1_skip3:
    s_mov_b64 exec, -1
    s_branch L_m1_loop
L_m1_done:
    v_max3_f32 v93, v144, v148, v152
    v_max_f32 v93, v93, v156
    v_mov_b32 v94, v93
    s_nop 1
    v_permlane32_swap_b32 v93, v94
    v_max_f32 v93, v93, v94
    v_sub_f32 v144, v144, v93
    v_sub_f32 v148, v148, v93
    v_sub_f32 v152, v152, v93
    v_sub_f32 v156, v156, v93
    v_exp_f32 v144, v144
    v_exp_f32 v148, v148
    v_exp_f32 v152, v152
    v_exp_f32 v156, v156
    v_mul_f32 v16, v144, v146
    v_fmac_f32 v16, v148, v150
    v_fmac_f32 v16, v152, v154
    v_fmac_f32 v16, v156, v158
    v_mov_b32 v20, v16
    s_nop 1
    v_permlane32_swap_b32 v16, v20
    v_add_f32 v16, v16, v20
    v_rcp_f32 v16, v16
    s_nop 0
    v_mul_f32 v144, v144, v16
    v_mul_f32 v148, v148, v16
    v_mul_f32 v152, v152, v16
    v_mul_f32 v156, v156, v16
L_ml_join:
    s_barrier
    s_cmp_lg_u32 s90, 0
    s_cbranch_scc1 L_h1_slow
    buffer_load_dwordx4 v[128:131], v91, s[60:63], s5 offen offset:0 sc1
    buffer_load_dwordx4 v[132:135], v91, s[60:63], s5 offen offset:1024 sc1
    buffer_load_dwordx4 v[136:139], v91, s[60:63], s5 offen offset:2048 sc1
    buffer_load_dwordx4 v[140:143], v91, s[60:63], s5 offen offset:3072 sc1
    s_mov_b32 s85, 24
L_h1_loop:
    s_waitcnt vmcnt(0)
    v_bitop3_b32 v56, v129, v131, s72 bitop3:0x7e
    v_bitop3_b32 v57, v133, v135, s72 bitop3:0x7e
    v_bitop3_b32 v58, v137, v139, s72 bitop3:0x7e
    v_bitop3_b32 v59, v141, v143, s72 bitop3:0x7e
    v_or3_b32 v93, v56, v57, v58
    v_or_b32 v93, v93, v59
    v_cmp_ne_u32 vcc, 0, v93
    s_nop 0
    s_cmp_eq_u64 vcc, 0
    s_cbranch_scc1 L_h1_done
    v_cmp_ne_u32 s[28:29], 0, v56
    v_cmp_ne_u32 s[30:31], 0, v57
    v_cmp_ne_u32 s[32:33], 0, v58
    v_cmp_ne_u32 s[34:35], 0, v59
    s_sub_u32 s85, s85, 1
    s_cbranch_scc1 L_h1_slow
    s_mov_b64 exec, s[28:29]
    s_cbranch_execz L_h1_skip0
    buffer_load_dwordx4 v[128:131], v91, s[60:63], s5 offen offset:0 sc1
L_h1_skip0:
    s_mov_b64 exec, s[30:31]
    s_cbranch_execz L_h1_skip1
    buffer_load_dwordx4 v[132:135], v91, s[60:63], s5 offen offset:1024 sc1
L_h1_skip1:
    s_mov_b64 exec, s[32:33]
    s_cbranch_execz L_h1_skip2
    buffer_load_dwordx4 v[136:139], v91, s[60:63], s5 offen offset:2048 sc1
L_h1_skip2:
    s_mov_b64 exec, s[34:35]
    s_cbranch_execz L_h1_skip3
    buffer_load_dwordx4 v[140:143], v91, s[60:63], s5 offen offset:3072 sc1
L_h1_skip3:
    s_mov_b64 exec, -1
    s_branch L_h1_loop
L_h1_done:
L_h1_have:
    v_mul_f32 v17, v144, v128
    v_mul_f32 v18, v144, v130
    v_fmac_f32 v17, v148, v132
    v_fmac_f32 v18, v148, v134
    v_fmac_f32 v17, v152, v136
    v_fmac_f32 v18, v152, v138
    v_fmac_f32 v17, v156, v140
    v_fmac_f32 v18, v156, v142
    v_mov_b32 v21, v17
    v_mov_b32 v22, v18
    v_mov_b32 v94, 0
    v_permlane32_swap_b32 v17, v21
    v_permlane32_swap_b32 v18, v22
    v_mov_b32 v93, 0
    v_add_f32 v17, v17, v21
    v_add_f32 v18, v18, v22
    v_cvt_pk_bf16_f32 v17, v17, v18
    ds_write_b32 v89, v17 offset:4480
    ds_write_b32 v93, v94 offset:4608
L_hop1_join:
    s_waitcnt lgkmcnt(0)
    s_barrier
    s_cmp_eq_u32 s71, 0
    s_cbranch_scc1 L_hop2
    v_mov_b32 v93, 0
    ds_read_b32 v94, v93 offset:4608
    ds_read_b128 v[80:83], v88 offset:4480
    ds_read_b128 v[84:87], v88 offset:4544
    s_waitcnt lgkmcnt(2)
    v_readfirstlane_b32 s76, v94
    s_nop 0
    s_cmp_lg_u32 s76, 0
    s_cbranch_scc1 L_y_slow
    s_waitcnt lgkmcnt(1)
    v_mfma_f32_16x16x32_bf16 v[16:19], v[80:83], a[128:131], 0
    v_mfma_f32_16x16x32_bf16 v[20:23], v[80:83], a[132:135], 0
    v_mfma_f32_16x16x32_bf16 v[24:27], v[80:83], a[136:139], 0
    v_mfma_f32_16x16x32_bf16 v[28:31], v[80:83], a[140:143], 0
    v_mfma_f32_16x16x32_bf16 v[32:35], v[80:83], a[144:147], 0
    v_mfma_f32_16x16x32_bf16 v[36:39], v[80:83], a[148:151], 0
    v_mfma_f32_16x16x32_bf16 v[40:43], v[80:83], a[152:155], 0
    v_mfma_f32_16x16x32_bf16 v[44:47], v[80:83], a[156:159], 0
    v_mfma_f32_16x16x32_bf16 v[48:51], v[80:83], a[160:163], 0
    v_mfma_f32_16x16x32_bf16 v[52:55], v[80:83], a[164:167], 0
    s_waitcnt lgkmcnt(0)
    v_mfma_f32_16x16x32_bf16 v[16:19], v[84:87], a[168:171], v[16:19]
    v_mfma_f32_16x16x32_bf16 v[20:23], v[84:87], a[172:175], v[20:23]
    v_mfma_f32_16x16x32_bf16 v[24:27], v[84:87], a[176:179], v[24:27]
    v_mfma_f32_16x16x32_bf16 v[28:31], v[84:87], a[180:183], v[28:31]
    v_mfma_f32_16x16x32_bf16 v[32:35], v[84:87], a[184:187], v[32:35]
    v_mfma_f32_16x16x32_bf16 v[36:39], v[84:87], a[188:191], v[36:39]
    v_mfma_f32_16x16x32_bf16 v[40:43], v[84:87], a[192:195], v[40:43]
    v_mfma_f32_16x16x32_bf16 v[44:47], v[84:87], a[196:199], v[44:47]
    v_mfma_f32_16x16x32_bf16 v[48:51], v[84:87], a[200:203], v[48:51]
    v_mfma_f32_16x16x32_bf16 v[52:55], v[84:87], a[204:207], v[52:55]
    s_mov_b32 s77, 0x55555555
    s_cmp_eq_u32 s71, 1
    s_cselect_b32 s75, s77, 0x5555
    v_cndmask_b32 v93, v16, v20, s[86:87]
    v_cndmask_b32 v94, v24, v28, s[86:87]
    v_cndmask_b32 v64, v93, v94, s[88:89]
    v_fma_f32 v64, v64, s94, v78
    v_cndmask_b32 v93, v32, v36, s[86:87]
    v_cndmask_b32 v94, v40, v44, s[86:87]
    v_cndmask_b32 v68, v93, v94, s[88:89]
    v_fma_f32 v68, v68, s94, v79
    v_cndmask_b32 v72, v48, v52, s[86:87]
    v_fma_f32 v72, v72, s94, v15
    v_mov_b32_dpp v66, v64 quad_perm:[1,1,3,3] row_mask:0xf bank_mask:0xf
    v_mov_b32_dpp v70, v68 quad_perm:[1,1,3,3] row_mask:0xf bank_mask:0xf
    v_mov_b32_dpp v74, v72 quad_perm:[1,1,3,3] row_mask:0xf bank_mask:0xf
    s_mov_b32 exec_lo, s77
    s_mov_b32 exec_hi, s77
    buffer_store_dwordx4 v[64:67], v12, s[60:63], s8 offen sc1
    buffer_store_dwordx4 v[68:71], v13, s[60:63], s8 offen sc1
    s_mov_b32 exec_lo, s75
    s_mov_b32 exec_hi, 0
    buffer_store_dwordx4 v[72:75], v14, s[60:63], s8 offen sc1
    s_mov_b64 exec, -1
    s_cmp_lg_u32 s91, 0
    s_cbranch_scc1 L_finish
    s_add_u32 s75, s4, 4194304
    buffer_store_dwordx4 v[104:107], v11, s[60:63], s75 offen sc1
    s_cmp_lg_u32 s71, 1
    s_cbranch_scc1 L_slow1_late
    s_add_u32 s75, s13, 4194304
    buffer_store_dwordx4 v[116:119], v11, s[60:63], s75 offen sc1
L_slow1_late:
    s_cmp_lg_u32 s71, 2
    s_cbranch_scc1 L_slow2_late
    s_add_u32 s75, s6, 4194304
    s_mov_b64 exec, 0x11
    buffer_store_dwordx4 v[120:123], v2, s[60:63], s75 offen sc1
    s_mov_b64 exec, -1
L_slow2_late:
    s_branch L_finish
L_y_slow:
    s_waitcnt lgkmcnt(0)
    s_add_u32 s75, s4, 4194304
    buffer_store_dwordx4 v[104:107], v11, s[60:63], s75 offen sc1
    s_cmp_lg_u32 s71, 1
    s_cbranch_scc1 L_slow1_early
    s_add_u32 s75, s13, 4194304
    buffer_store_dwordx4 v[116:119], v11, s[60:63], s75 offen sc1
L_slow1_early:
    s_cmp_lg_u32 s71, 2
    s_cbranch_scc1 L_slow2_early
    s_add_u32 s75, s6, 4194304
    s_mov_b64 exec, 0x11
    buffer_store_dwordx4 v[120:123], v2, s[60:63], s75 offen sc1
    s_mov_b64 exec, -1
L_slow2_early:
    s_mov_b32 s91, 1
    s_barrier
    s_branch L_hop1_join
L_h1_slow:
    v_mov_b32 v94, 1
    v_mov_b32 v93, 0
    ds_write_b32 v93, v94 offset:4608
    s_waitcnt lgkmcnt(0)
    s_barrier
    s_barrier
    s_xor_b32 s5, s5, 4194304
    s_xor_b32 s7, s7, 4194304
    buffer_load_dwordx4 v[128:131], v91, s[60:63], s5 offen offset:0 sc1
    buffer_load_dwordx4 v[132:135], v91, s[60:63], s5 offen offset:1024 sc1
    buffer_load_dwordx4 v[136:139], v91, s[60:63], s5 offen offset:2048 sc1
    buffer_load_dwordx4 v[140:143], v91, s[60:63], s5 offen offset:3072 sc1
    buffer_load_dwordx4 v[144:147], v90, s[60:63], s7 offen offset:0 sc1
    buffer_load_dwordx4 v[148:151], v90, s[60:63], s7 offen offset:256 sc1
    buffer_load_dwordx4 v[152:155], v90, s[60:63], s7 offen offset:512 sc1
    buffer_load_dwordx4 v[156:159], v90, s[60:63], s7 offen offset:768 sc1
    s_mov_b32 s85, 100000
L_h1s_loop:
    s_waitcnt vmcnt(0)
    v_bitop3_b32 v56, v129, v131, s72 bitop3:0x7e
    v_bitop3_b32 v57, v133, v135, s72 bitop3:0x7e
    v_bitop3_b32 v58, v137, v139, s72 bitop3:0x7e
    v_bitop3_b32 v59, v141, v143, s72 bitop3:0x7e
    v_bitop3_b32 v60, v145, v147, s72 bitop3:0x7e
    v_bitop3_b32 v61, v149, v151, s72 bitop3:0x7e
    v_bitop3_b32 v62, v153, v155, s72 bitop3:0x7e
    v_bitop3_b32 v63, v157, v159, s72 bitop3:0x7e
    v_or3_b32 v93, v56, v57, v58
    v_or3_b32 v93, v93, v59, v60
    v_or3_b32 v93, v93, v61, v62
    v_or_b32 v93, v93, v63
    v_cmp_ne_u32 vcc, 0, v93
    s_nop 0
    s_cmp_eq_u64 vcc, 0
    s_cbranch_scc1 L_h1s_done
    v_cmp_ne_u32 s[28:29], 0, v56
    v_cmp_ne_u32 s[30:31], 0, v57
    v_cmp_ne_u32 s[32:33], 0, v58
    v_cmp_ne_u32 s[34:35], 0, v59
    v_cmp_ne_u32 s[36:37], 0, v60
    v_cmp_ne_u32 s[38:39], 0, v61
    v_cmp_ne_u32 s[40:41], 0, v62
    v_cmp_ne_u32 s[42:43], 0, v63
    s_sub_u32 s85, s85, 1
    s_cbranch_scc1 L_h1s_done
    s_xor_b32 s5, s5, 4194304
    s_xor_b32 s7, s7, 4194304
    s_mov_b64 exec, s[28:29]
    s_cbranch_execz L_h1s_skip0
    buffer_load_dwordx4 v[128:131], v91, s[60:63], s5 offen offset:0 sc1
L_h1s_skip0:
    s_mov_b64 exec, s[30:31]
    s_cbranch_execz L_h1s_skip1
    buffer_load_dwordx4 v[132:135], v91, s[60:63], s5 offen offset:1024 sc1
L_h1s_skip1:
    s_mov_b64 exec, s[32:33]
    s_cbranch_execz L_h1s_skip2
    buffer_load_dwordx4 v[136:139], v91, s[60:63], s5 offen offset:2048 sc1
L_h1s_skip2:
    s_mov_b64 exec, s[34:35]
    s_cbranch_execz L_h1s_skip3
    buffer_load_dwordx4 v[140:143], v91, s[60:63], s5 offen offset:3072 sc1
L_h1s_skip3:
    s_mov_b64 exec, s[36:37]
    s_cbranch_execz L_h1s_skip4
    buffer_load_dwordx4 v[144:147], v90, s[60:63], s7 offen offset:0 sc1
L_h1s_skip4:
    s_mov_b64 exec, s[38:39]
    s_cbranch_execz L_h1s_skip5
    buffer_load_dwordx4 v[148:151], v90, s[60:63], s7 offen offset:256 sc1
L_h1s_skip5:
    s_mov_b64 exec, s[40:41]
    s_cbranch_execz L_h1s_skip6
    buffer_load_dwordx4 v[152:155], v90, s[60:63], s7 offen offset:512 sc1
L_h1s_skip6:
    s_mov_b64 exec, s[42:43]
    s_cbranch_execz L_h1s_skip7
    buffer_load_dwordx4 v[156:159], v90, s[60:63], s7 offen offset:768 sc1
L_h1s_skip7:
    s_mov_b64 exec, -1
    s_branch L_h1s_loop
L_h1s_done:
    v_max3_f32 v93, v144, v148, v152
    v_max_f32 v93, v93, v156
    v_mov_b32 v94, v93
    s_nop 1
    v_permlane32_swap_b32 v93, v94
    v_max_f32 v93, v93, v94
    v_sub_f32 v144, v144, v93
    v_sub_f32 v148, v148, v93
    v_sub_f32 v152, v152, v93
    v_sub_f32 v156, v156, v93
    v_exp_f32 v144, v144
    v_exp_f32 v148, v148
    v_exp_f32 v152, v152
    v_exp_f32 v156, v156
    v_mul_f32 v16, v144, v146
    v_fmac_f32 v16, v148, v150
    v_fmac_f32 v16, v152, v154
    v_fmac_f32 v16, v156, v158
    v_mov_b32 v20, v16
    s_nop 1
    v_permlane32_swap_b32 v16, v20
    v_add_f32 v16, v16, v20
    v_rcp_f32 v16, v16
    s_nop 0
    v_mul_f32 v144, v144, v16
    v_mul_f32 v148, v148, v16
    v_mul_f32 v152, v152, v16
    v_mul_f32 v156, v156, v16
    s_branch L_h1_have
L_ml_late:
    s_mov_b32 s90, 1
    s_branch L_ml_join
L_hop2:
    s_cmp_ge_u32 s73, 56
    s_cbranch_scc1 L_finish
    buffer_load_dwordx4 v[128:131], v91, s[60:63], s9 offen offset:0 sc1
    buffer_load_dwordx4 v[132:135], v91, s[60:63], s9 offen offset:1024 sc1
    buffer_load_dwordx4 v[136:139], v91, s[60:63], s9 offen offset:2048 sc1
    buffer_load_dwordx4 v[140:143], v91, s[60:63], s9 offen offset:3072 sc1
    s_mov_b32 s85, 100000
L_h2_loop:
    s_waitcnt vmcnt(0)
    v_bitop3_b32 v56, v129, v131, s72 bitop3:0x7e
    v_bitop3_b32 v57, v133, v135, s72 bitop3:0x7e
    v_bitop3_b32 v58, v137, v139, s72 bitop3:0x7e
    v_bitop3_b32 v59, v141, v143, s72 bitop3:0x7e
    v_or3_b32 v93, v56, v57, v58
    v_or_b32 v93, v93, v59
    v_cmp_ne_u32 vcc, 0, v93
    s_nop 0
    s_cmp_eq_u64 vcc, 0
    s_cbranch_scc1 L_h2_done
    v_cmp_ne_u32 s[28:29], 0, v56
    v_cmp_ne_u32 s[30:31], 0, v57
    v_cmp_ne_u32 s[32:33], 0, v58
    v_cmp_ne_u32 s[34:35], 0, v59
    s_sub_u32 s85, s85, 1
    s_cbranch_scc1 L_h2_done
    s_mov_b64 exec, s[28:29]
    s_cbranch_execz L_h2_skip0
    buffer_load_dwordx4 v[128:131], v91, s[60:63], s9 offen offset:0 sc1
L_h2_skip0:
    s_mov_b64 exec, s[30:31]
    s_cbranch_execz L_h2_skip1
    buffer_load_dwordx4 v[132:135], v91, s[60:63], s9 offen offset:1024 sc1
L_h2_skip1:
    s_mov_b64 exec, s[32:33]
    s_cbranch_execz L_h2_skip2
    buffer_load_dwordx4 v[136:139], v91, s[60:63], s9 offen offset:2048 sc1
L_h2_skip2:
    s_mov_b64 exec, s[34:35]
    s_cbranch_execz L_h2_skip3
    buffer_load_dwordx4 v[140:143], v91, s[60:63], s9 offen offset:3072 sc1
L_h2_skip3:
    s_mov_b64 exec, -1
    s_branch L_h2_loop
L_h2_done:
    v_add_f32 v128, v128, v132
    v_add_f32 v136, v136, v140
    v_add_f32 v130, v130, v134
    v_add_f32 v138, v138, v142
    v_add_f32 v96, v128, v136
    v_add_f32 v98, v130, v138
    s_nop 0
    v_add_f32_dpp v96, v96, v96 row_ror:4 row_mask:0xf bank_mask:0xf
    v_add_f32_dpp v98, v98, v98 row_ror:4 row_mask:0xf bank_mask:0xf
    s_nop 0
    v_add_f32_dpp v96, v96, v96 row_ror:8 row_mask:0xf bank_mask:0xf
    v_add_f32_dpp v98, v98, v98 row_ror:8 row_mask:0xf bank_mask:0xf
    v_mov_b32 v97, v96
    v_mov_b32 v99, v98
    s_nop 0
    v_permlane16_swap_b32 v96, v97
    v_permlane16_swap_b32 v98, v99
    v_add_f32 v96, v96, v97
    v_add_f32 v98, v98, v99
    v_mov_b32 v97, v96
    v_mov_b32 v99, v98
    s_nop 0
    v_permlane32_swap_b32 v96, v97
    v_permlane32_swap_b32 v98, v99
    v_add_f32 v96, v96, v97
    v_add_f32 v98, v98, v99
    v_lshlrev_b32 v93, 2, v1
    v_cvt_pk_bf16_f32 v96, v96, v98
    s_mov_b64 exec, 0xf
    buffer_store_dword v96, v93, s[64:67], s11 offen
    s_cmp_lg_u32 s73, 0
    s_cbranch_scc1 L_finish
    s_mov_b64 exec, 1
    s_lshl_b32 s75, s70, 8
    v_mov_b32 v100, s72
    v_mov_b32 v101, 0
    buffer_store_dword v100, v101, s[60:63], s75 offen sc1
L_finish:
L_exit:
    s_endpgm
.section .rodata,"a"
.p2align 6
.amdhsa_kernel gated_mix__gqa_block_cached__dense_activation_relu__decode_kernel
  .amdhsa_next_free_vgpr 512
  .amdhsa_next_free_sgpr 102
  .amdhsa_accum_offset 256
  .amdhsa_group_segment_fixed_size 0
  .amdhsa_kernarg_size 96
  .amdhsa_user_sgpr_count 2
  .amdhsa_user_sgpr_kernarg_segment_ptr 1
  .amdhsa_system_sgpr_workgroup_id_x 1
.end_amdhsa_kernel
```
